```python
import torch

def _softmax(x, axis=-1):
    return torch.softmax(x, dim=axis)

def _gelu(x):
    return torch.nn.functional.gelu(x, approximate='tanh')

def _silu(x):
    return torch.nn.functional.silu(x)

def _sigmoid(x):
    return torch.sigmoid(x)

def _layernorm(x, axis=-1, eps=1e-05):
    m = x.mean(dim=axis, keepdim=True)
    v = x.var(dim=axis, keepdim=True, unbiased=False)
    return (x - m) / torch.sqrt(v + eps)

def _scatter_add(tgt, idx, src, axis=0):
    return tgt.clone().index_add_(axis, idx, src)

def _segment_sum(src, seg, n):
    out = torch.zeros((n,) + src.shape[1:], dtype=src.dtype)
    return out.index_add_(0, seg, src)

def _pad(x, pw):
    flat = tuple((v for pair in reversed(pw) for v in pair))
    return torch.nn.functional.pad(x, flat)
kernel_name = 'adaLN_cond__sliding_block_cached__geglu_ffn__decode'

def setup_inputs():

    _w = lambda a: (lambda t: t.to(torch.bfloat16) if t.is_floating_point() else t)(torch.as_tensor(a))

    def _A_setup():
        B, Sq, D = (1, 1, 512)
        Hq, Hkv, Sk, Dh = (32, 8, 65536, 128)
        assert Hq % Hkv == 0, (Hq, Hkv)
        return {'x': _w((lambda *s: torch.randn(*s, dtype=torch.bfloat16) * 0.1)(B, Sq, D)), 'k_cache': _w((lambda *s: torch.randn(*s, dtype=torch.bfloat16) * 0.8)(B, Hkv, Sk, Dh)), 'v_cache': _w((lambda *s: torch.randn(*s, dtype=torch.bfloat16) * 1.6)(B, Hkv, Sk, Dh)), 'wq': _w((lambda *s: torch.randn(*s, dtype=torch.bfloat16) * 0.8)(D, Hq * Dh) * D ** (-0.5)), 'wo': _w((lambda *s: torch.randn(*s, dtype=torch.bfloat16) * 1.6)(Hq * Dh, D) * (Hq * Dh) ** (-0.5))}
    _A_in = _A_setup()

    def _B_setup():
        B, S, D, F = (1, 1, 512, 1792)
        return {'x': _w((lambda *s: torch.randn(*s, dtype=torch.bfloat16) * 0.1)(B, S, D)), 'w_gate': _w((lambda *s: torch.randn(*s, dtype=torch.bfloat16) * 0.2)(D, F)), 'w_up': _w((lambda *s: torch.randn(*s, dtype=torch.bfloat16) * 0.2)(D, F)), 'w_down': _w((lambda *s: torch.randn(*s, dtype=torch.bfloat16) * 0.2)(F, D))}
    _B_in = _B_setup()
    return {'A_x': _A_in['x'], 'A_k_cache': _A_in['k_cache'], 'A_v_cache': _A_in['v_cache'], 'A_wq': _A_in['wq'], 'A_wo': _A_in['wo'], 'B_x': _B_in['x'], 'B_w_gate': _B_in['w_gate'], 'B_w_up': _B_in['w_up'], 'B_w_down': _B_in['w_down'], 'c': _w((lambda *s: torch.randn(*s, dtype=torch.bfloat16) * 0.4)(1, 512) * 8.0), 'w_mod': _w((lambda *s: torch.randn(*s, dtype=torch.bfloat16) * 0.4)(512, 6 * 512) * 512 ** (-0.5) * 8.0)}

def reference(A_x, A_k_cache, A_v_cache, A_wq, A_wo, B_x, B_w_gate, B_w_up, B_w_down, c, w_mod):

    def _A_ref(x, k_cache, v_cache, wq, wo):
        B, Sq, D = x.shape
        Hq, Dh = (32, 128)
        Hkv, Sk = (k_cache.shape[1], k_cache.shape[2])
        W = min(4096, max(256, Sk // 4))
        rep = Hq // Hkv
        q = (lambda x, *d: x.permute(*d))((x @ wq).reshape(B, Sq, Hq, Dh), 0, 2, 1, 3)
        k = (lambda x, n, axis: torch.repeat_interleave(x, n, dim=axis))(k_cache[:, :, Sk - W:, :], rep, axis=1)
        v = (lambda x, n, axis: torch.repeat_interleave(x, n, dim=axis))(v_cache[:, :, Sk - W:, :], rep, axis=1)
        scores = torch.einsum('bhqd,bhkd->bhqk', q, k) * Dh ** (-0.5)
        p = _softmax(scores, axis=-1)
        o = torch.einsum('bhqk,bhkd->bhqd', p, v)
        return (lambda x, *d: x.permute(*d))(o, 0, 2, 1, 3).reshape(B, Sq, Hq * Dh) @ wo

    def _B_ref(x, w_gate, w_up, w_down):
        return _gelu(x @ w_gate) * (x @ w_up) @ w_down
    x = A_x
    mod = (_silu(c) @ w_mod).reshape(c.shape[0], 6, 1, -1)
    sa, ca, ga, sb, cb, gb = (mod[:, 0].clone(), mod[:, 1].clone(), mod[:, 2].clone(), mod[:, 3].clone(), mod[:, 4].clone(), mod[:, 5].clone())
    h = _layernorm(x, axis=-1) * (1 + ca) + sa
    x = x + ga * _A_ref(h, A_k_cache, A_v_cache, A_wq, A_wo)
    h = _layernorm(x, axis=-1) * (1 + cb) + sb
    x = x + gb * _B_ref(h, B_w_gate, B_w_up, B_w_down)
    return x
```

```asm
; @launch grid=(256,1,1) block=(512,1,1) lds=32768
.amdgcn_target "amdgcn-amd-amdhsa--gfx950"
.text
.globl adaLN_cond__sliding_block_cached__geglu_ffn__decode_kernel
.p2align 8
.type adaLN_cond__sliding_block_cached__geglu_ffn__decode_kernel,@function
adaLN_cond__sliding_block_cached__geglu_ffn__decode_kernel:
  s_load_dwordx16 s[4:19], s[0:1], 0
  s_load_dwordx8 s[20:27], s[0:1], 64
  s_load_dwordx4 s[28:31], s[0:1], 96
  s_getpc_b64 s[44:45]
  s_cmp_ge_u32 s2, 256
  s_cbranch_scc1 L_exit
  v_lshrrev_b32 v4, 6, v0
  v_and_b32 v1, 63, v0
  v_readfirstlane_b32 s49, v4
  v_and_b32 v2, 15, v0
  v_lshrrev_b32 v3, 4, v1
  s_mov_b32 s50, 0x05040100
  s_mov_b32 s51, 0x07060302
  s_mov_b32 s60, 0xffff0000
  s_mov_b32 s61, 0x07060501
  s_mov_b32 s62, 0x07060502
  s_mov_b32 s63, 0x07060503
  s_mov_b32 s64, 0x0c04000c
  s_mov_b32 s65, 0x04020100
  s_mov_b32 s54, 600000
  s_mov_b32 s34, 4194304
  s_mov_b32 s35, 0x20000
  s_mov_b32 s39, 0x20000
  s_mov_b32 s42, 1024
  s_mov_b32 s43, 0x20000
  v_lshrrev_b32 v5, 3, v2
  v_and_b32 v6, 7, v2
  s_and_b32 s69, s49, 3
  s_cmp_ge_u32 s2, 128
  s_cbranch_scc1 L_attn
  s_cmp_lg_u32 s49, 3
  s_cbranch_scc1 L_na
  s_and_b32 s44, s44, 0xffffff00
  s_mov_b32 s46, L_exit - adaLN_cond__sliding_block_cached__geglu_ffn__decode_kernel
  s_mov_b32 s47, 0x20000
  s_bfe_u32 s52, s2, 0x40003
  s_xor_b32 s52, s52, 0
  s_lshl_b32 s52, s52, 10
  v_lshlrev_b32 v7, 4, v1
  buffer_load_dwordx4 v[212:215], v7, s[44:47], s52 offen
L_na:
  s_cmp_ge_u32 s49, 4
  s_cbranch_scc1 L_roleB
  s_lshr_b32 s52, s2, 3
  s_lshl_b32 s53, 1, s52
  s_and_b32 s53, s53, 16552
  s_cbranch_scc1 L_notask
  s_cmp_eq_u32 s52, 1
  s_cselect_b32 s53, 104, 0
  s_add_u32 s66, s2, s53
  s_and_b32 s57, s66, 15
  s_cmp_lt_u32 s66, 64
  s_cselect_b32 s52, 0, 8
  s_add_u32 s57, s57, s52
  s_bfe_u32 s58, s66, 0x20004
  s_lshl_b32 s59, s57, 7
  s_add_u32 s59, s59, 2048
  s_lshl_b32 s56, s57, 8
  s_lshl_b32 s52, s58, 18
  s_add_u32 s56, s56, s52
  s_add_u32 s56, s56, 2129920
  s_lshl_b32 s52, s58, 7
  s_lshl_b32 s53, s69, 5
  s_add_u32 s52, s52, s53
  v_lshlrev_b32 v7, 4, v5
  v_lshl_add_u32 v7, v3, 2, v7
  v_add_u32 v7, s52, v7
  v_lshlrev_b32 v8, 1, v7
  v_mul_u32_u24 v9, 6144, v7
  v_lshl_add_u32 v9, v6, 4, v9
  s_add_u32 s66, s59, 6144
  s_mov_b32 s38, 3145728
  s_add_u32 s67, s59, 12288
  s_add_u32 s68, s59, 18432
  s_waitcnt lgkmcnt(0)
  s_load_dword s55, s[30:31], 0
  s_mov_b32 s32, s30
  s_mov_b32 s33, s31
  s_mov_b32 s36, s24
  s_mov_b32 s37, s25
  s_mov_b32 s40, s22
  s_mov_b32 s41, s23
  buffer_load_dwordx2 v[10:11], v8, s[40:43], 0 offen
  buffer_load_dwordx4 v[32:35], v9, s[36:39], s59 offen nt
  buffer_load_dwordx4 v[36:39], v9, s[36:39], s66 offen nt
  buffer_load_dwordx4 v[40:43], v9, s[36:39], s67 offen nt
  buffer_load_dwordx4 v[44:47], v9, s[36:39], s68 offen nt
  s_branch L_A_body
L_attn:
  s_cmp_lt_u32 s49, 4
  s_cbranch_scc1 L_attn2
  s_setprio 3
  s_and_b32 s57, s2, 15
  s_bfe_u32 s58, s2, 0x30004
  s_lshl_b32 s59, s57, 7
  s_lshl_b32 s56, s57, 8
  s_lshl_b32 s52, s58, 17
  s_add_u32 s56, s56, s52
  s_add_u32 s56, s56, 2097152
  s_lshl_b32 s52, s58, 6
  s_lshl_b32 s53, s69, 4
  s_add_u32 s52, s52, s53
  v_lshlrev_b32 v7, 3, v5
  v_lshl_add_u32 v7, v3, 1, v7
  v_add_u32 v7, s52, v7
  v_lshlrev_b32 v8, 1, v7
  v_mul_u32_u24 v9, 6144, v7
  v_lshl_add_u32 v9, v6, 4, v9
  s_add_u32 s66, s59, 6144
  s_mov_b32 s38, 3145728
  s_lshl_b32 s67, s52, 1
  s_waitcnt lgkmcnt(0)
  s_load_dword s55, s[30:31], 0
  s_mov_b32 s32, s30
  s_mov_b32 s33, s31
  s_mov_b32 s36, s24
  s_mov_b32 s37, s25
  s_mov_b32 s40, s22
  s_mov_b32 s41, s23
  s_load_dwordx8 s[12:19], s[22:23], s67
  buffer_load_dwordx4 v[32:35], v9, s[36:39], s59 offen nt
  buffer_load_dwordx4 v[36:39], v9, s[36:39], s66 offen nt
  v_and_b32 v12, 1, v2
  v_cmp_eq_u32 vcc, 1, v12
  v_mov_b32 v14, 0xffff
  v_mov_b32 v15, s60
  v_cndmask_b32 v14, v14, v15, vcc
  v_lshrrev_b32 v12, 1, v6
  v_cmp_eq_u32 vcc, 0, v12
  s_nop 1
  v_cndmask_b32 v16, 0, v14, vcc
  v_cmp_eq_u32 vcc, 1, v12
  s_nop 1
  v_cndmask_b32 v17, 0, v14, vcc
  v_cmp_eq_u32 vcc, 2, v12
  s_nop 1
  v_cndmask_b32 v18, 0, v14, vcc
  v_cmp_eq_u32 vcc, 3, v12
  s_nop 1
  v_cndmask_b32 v19, 0, v14, vcc
  v_and_b32 v13, 1, v3
  v_lshlrev_b32 v12, 3, v6
  v_lshl_add_u32 v12, v13, 2, v12
  v_mul_u32_u24 v12, 80, v12
  v_mad_u32_u24 v12, v6, 32, v12
  v_lshl_add_u32 v12, v5, 2, v12
  s_lshl_b32 s52, s69, 3
  s_add_u32 s52, s52, 4096
  v_add_u32 v12, s52, v12
  v_lshlrev_b32 v15, 4, v2
  v_lshl_add_u32 v15, v3, 13, v15
  v_lshl_add_u32 v13, v2, 2, v3
  v_mul_u32_u24 v13, 80, v13
  v_lshrrev_b32 v4, 1, v2
  v_mad_u32_u24 v13, v4, 32, v13
  v_add_u32 v13, 4096, v13
  s_waitcnt lgkmcnt(0)
  s_mul_i32 s48, s55, 0x9E3779B1
  s_add_u32 s48, s48, 0x7F4A7C15
  v_mov_b32 v31, s48
  s_mov_b64 exec, 0xff
  v_mov_b32 v10, s12
  s_lshl_b64 exec, exec, 8
  v_mov_b32 v10, s16
  s_lshl_b64 exec, exec, 8
  v_mov_b32 v10, s13
  s_lshl_b64 exec, exec, 8
  v_mov_b32 v10, s17
  s_lshl_b64 exec, exec, 8
  v_mov_b32 v10, s14
  s_lshl_b64 exec, exec, 8
  v_mov_b32 v10, s18
  s_lshl_b64 exec, exec, 8
  v_mov_b32 v10, s15
  s_lshl_b64 exec, exec, 8
  v_mov_b32 v10, s19
  s_mov_b64 exec, -1
  s_load_dwordx8 s[12:19], s[0:1], 32
  v_lshlrev_b32 v20, 16, v10
  v_and_b32 v21, s60, v10
  v_mul_f32 v24, 0xbfb8aa3b, v20
  v_mul_f32 v25, 0xbfb8aa3b, v21
  v_exp_f32 v24, v24
  v_exp_f32 v25, v25
  v_add_f32 v24, 1.0, v24
  v_add_f32 v25, 1.0, v25
  v_rcp_f32 v24, v24
  v_rcp_f32 v25, v25
  v_mul_f32 v20, v20, v24
  v_mul_f32 v21, v21, v25
  v_cvt_pk_bf16_f32 v20, v20, v20
  v_cvt_pk_bf16_f32 v21, v21, v21
  v_and_b32 v48, v20, v16
  v_and_b32 v49, v20, v17
  v_and_b32 v50, v20, v18
  v_and_b32 v51, v20, v19
  s_waitcnt vmcnt(1)
  s_nop 0
  v_mfma_f32_16x16x32_bf16 v[64:67], v[48:51], v[32:35], 0
  v_and_b32 v52, v21, v16
  v_and_b32 v53, v21, v17
  v_and_b32 v54, v21, v18
  v_and_b32 v55, v21, v19
  s_waitcnt vmcnt(0)
  s_nop 0
  v_mfma_f32_16x16x32_bf16 v[64:67], v[52:55], v[36:39], v[64:67]
  s_mov_b32 exec_lo, 0x00FF00FF
  s_mov_b32 exec_hi, 0xFF00FF00
  s_nop 5
  ds_write2_b32 v12, v64, v65 offset0:0 offset1:20
  ds_write2_b32 v12, v66, v67 offset0:40 offset1:60
  s_mov_b64 exec, -1
  s_waitcnt lgkmcnt(0)
  s_barrier
  s_cmp_lg_u32 s69, 0
  s_cbranch_scc1 L_VA_done
  ds_read_b128 v[32:35], v13 offset:0
  ds_read_b128 v[36:39], v13 offset:16
  s_waitcnt lgkmcnt(0)
  v_pk_add_f32 v[32:33], v[32:33], v[36:37]
  v_pk_add_f32 v[34:35], v[34:35], v[38:39]
  v_pk_add_f32 v[32:33], v[32:33], v[34:35]
  v_add_f32 v20, v32, v33
  v_mov_b32 v21, v20
  s_nop 1
  v_permlane16_swap_b32 v20, v21
  v_mov_b32 v22, v20
  v_mov_b32 v23, v21
  s_nop 0
  v_permlane32_swap_b32 v20, v22
  v_permlane32_swap_b32 v21, v23
  v_perm_b32 v28, v20, v23, s61
  v_perm_b32 v29, v21, v23, s62
  v_perm_b32 v30, v22, v23, s63
  s_mov_b64 exec, 0xffff
  buffer_store_dwordx4 v[28:31], v15, s[32:35], s56 offen sc1
  s_mov_b64 exec, -1
L_VA_done:
  s_setprio 0
  s_barrier
L_attn2:
  s_sub_u32 s56, s2, 128
  s_and_b32 s57, s56, 7
  s_lshr_b32 s58, s56, 3
  s_lshl_b32 s52, s57, 24
  s_lshl_b32 s53, s58, 16
  s_add_u32 s52, s52, s53
  s_lshl_b32 s53, s69, 10
  s_add_u32 s52, s52, s53
  s_lshl_b32 s53, s57, 13
  s_add_u32 s52, s52, s53
  s_add_u32 s59, s52, 15728640
  s_mov_b32 s38, 0x8000000
  v_bfe_u32 v5, v1, 2, 2
  v_and_b32 v6, 3, v1
  s_cmp_ge_u32 s49, 4
  s_cbranch_scc1 L_vwave
  v_lshlrev_b32 v7, 8, v5
  v_lshl_add_u32 v7, v3, 6, v7
  v_lshl_add_u32 v7, v6, 4, v7
  s_waitcnt lgkmcnt(0)
  s_load_dword s55, s[30:31], 0
  s_mov_b32 s32, s30
  s_mov_b32 s33, s31
  s_mov_b32 s36, s6
  s_mov_b32 s37, s7
  s_waitcnt lgkmcnt(0)
  s_xor_b32 s52, s59, 0
  buffer_load_dwordx4 v[32:35], v7, s[36:39], s52 offen nt
  s_xor_b32 s52, s59, 4096
  buffer_load_dwordx4 v[36:39], v7, s[36:39], s52 offen nt
  s_xor_b32 s52, s59, 8192
  buffer_load_dwordx4 v[40:43], v7, s[36:39], s52 offen nt
  s_barrier
  s_barrier
  s_xor_b32 s52, s59, 12288
  buffer_load_dwordx4 v[44:47], v7, s[36:39], s52 offen nt
  s_xor_b32 s52, s59, 16384
  buffer_load_dwordx4 v[48:51], v7, s[36:39], s52 offen nt
  s_xor_b32 s52, s59, 20480
  buffer_load_dwordx4 v[52:55], v7, s[36:39], s52 offen nt
  s_xor_b32 s52, s59, 24576
  buffer_load_dwordx4 v[56:59], v7, s[36:39], s52 offen nt
  s_xor_b32 s52, s59, 28672
  buffer_load_dwordx4 v[60:63], v7, s[36:39], s52 offen nt
  s_xor_b32 s52, s59, 32768
  buffer_load_dwordx4 v[64:67], v7, s[36:39], s52 offen nt
  s_xor_b32 s52, s59, 36864
  buffer_load_dwordx4 v[68:71], v7, s[36:39], s52 offen nt
  s_xor_b32 s52, s59, 40960
  buffer_load_dwordx4 v[72:75], v7, s[36:39], s52 offen nt
  s_xor_b32 s52, s59, 45056
  buffer_load_dwordx4 v[76:79], v7, s[36:39], s52 offen nt
  s_xor_b32 s52, s59, 49152
  buffer_load_dwordx4 v[80:83], v7, s[36:39], s52 offen nt
  s_xor_b32 s52, s59, 53248
  buffer_load_dwordx4 v[84:87], v7, s[36:39], s52 offen nt
  s_xor_b32 s52, s59, 57344
  buffer_load_dwordx4 v[88:91], v7, s[36:39], s52 offen nt
  s_xor_b32 s52, s59, 61440
  buffer_load_dwordx4 v[92:95], v7, s[36:39], s52 offen nt
  s_branch L_K_body
L_roleB:
  s_and_b32 s57, s2, 7
  s_bfe_u32 s58, s2, 0x30003
  s_cmp_ge_u32 s2, 64
  s_cselect_b32 s52, 5, 0
  s_xor_b32 s58, s58, s52
  s_lshr_b32 s66, s2, 6
  v_lshl_add_u32 v7, v5, 5, v3
  s_lshl_b32 s52, s66, 2
  s_add_u32 s68, s52, s69
  s_lshl_b32 s52, s68, 6
  v_add_u32 v9, s52, v7
  v_lshlrev_b32 v9, 13, v9
  v_lshl_add_u32 v9, v6, 4, v9
  s_lshl_b32 s52, s57, 10
  s_lshl_b32 s53, s58, 7
  s_add_u32 s52, s52, s53
  v_add_u32 v9, s52, v9
  v_lshlrev_b32 v8, 4, v1
  s_lshl_b32 s52, s68, 4
  v_add_u32 v16, s52, v2
  v_lshl_add_u32 v17, v16, 2, v3
  v_lshlrev_b32 v18, 1, v17
  s_mov_b32 s38, 4194304
  s_waitcnt lgkmcnt(0)
  s_load_dword s55, s[30:31], 0
  s_mov_b32 s32, s30
  s_mov_b32 s33, s31
  s_mov_b32 s36, s10
  s_mov_b32 s37, s11
  s_mov_b32 s40, s4
  s_mov_b32 s41, s5
  buffer_load_dwordx4 v[20:23], v8, s[40:43], 0 offen
  buffer_load_ushort v19, v18, s[40:43], 0 offen
  buffer_load_dwordx4 v[32:35], v9, s[36:39], 0 offen offset:0 nt
  s_mov_b32 s52, 32768
  buffer_load_dwordx4 v[36:39], v9, s[36:39], s52 offen nt
  s_mov_b32 s52, 65536
  buffer_load_dwordx4 v[40:43], v9, s[36:39], s52 offen nt
  s_mov_b32 s52, 98304
  buffer_load_dwordx4 v[44:47], v9, s[36:39], s52 offen nt
  s_mov_b32 s52, 131072
  buffer_load_dwordx4 v[48:51], v9, s[36:39], s52 offen nt
  s_mov_b32 s52, 163840
  buffer_load_dwordx4 v[52:55], v9, s[36:39], s52 offen nt
  s_mov_b32 s52, 196608
  buffer_load_dwordx4 v[56:59], v9, s[36:39], s52 offen nt
  s_mov_b32 s52, 229376
  buffer_load_dwordx4 v[60:63], v9, s[36:39], s52 offen nt
  s_branch L_B_body
L_A_body:
  v_and_b32 v12, 1, v2
  v_cmp_eq_u32 vcc, 1, v12
  v_mov_b32 v14, 0xffff
  v_mov_b32 v15, s60
  v_cndmask_b32 v14, v14, v15, vcc
  v_lshrrev_b32 v12, 1, v6
  v_cmp_eq_u32 vcc, 0, v12
  s_nop 1
  v_cndmask_b32 v16, 0, v14, vcc
  v_cmp_eq_u32 vcc, 1, v12
  s_nop 1
  v_cndmask_b32 v17, 0, v14, vcc
  v_cmp_eq_u32 vcc, 2, v12
  s_nop 1
  v_cndmask_b32 v18, 0, v14, vcc
  v_cmp_eq_u32 vcc, 3, v12
  s_nop 1
  v_cndmask_b32 v19, 0, v14, vcc
  v_and_b32 v13, 1, v3
  v_lshlrev_b32 v12, 3, v6
  v_lshl_add_u32 v12, v13, 2, v12
  v_mul_u32_u24 v12, 80, v12
  v_mad_u32_u24 v12, v6, 32, v12
  v_lshl_add_u32 v12, v5, 2, v12
  s_lshl_b32 s52, s69, 3
  s_add_u32 s52, s52, 0
  v_add_u32 v12, s52, v12
  v_lshlrev_b32 v15, 4, v2
  v_lshl_add_u32 v15, v3, 13, v15
  v_lshl_add_u32 v13, v2, 2, v3
  v_mul_u32_u24 v13, 80, v13
  v_lshrrev_b32 v4, 1, v2
  v_mad_u32_u24 v13, v4, 32, v13
  s_waitcnt lgkmcnt(0)
  s_mul_i32 s48, s55, 0x9E3779B1
  s_add_u32 s48, s48, 0x7F4A7C15
  v_mov_b32 v31, s48
  s_waitcnt vmcnt(4)
  v_lshlrev_b32 v20, 16, v10
  v_and_b32 v21, s60, v10
  v_lshlrev_b32 v22, 16, v11
  v_and_b32 v23, s60, v11
  v_mul_f32 v24, 0xbfb8aa3b, v20
  v_mul_f32 v25, 0xbfb8aa3b, v21
  v_mul_f32 v26, 0xbfb8aa3b, v22
  v_mul_f32 v27, 0xbfb8aa3b, v23
  v_exp_f32 v24, v24
  v_exp_f32 v25, v25
  v_exp_f32 v26, v26
  v_exp_f32 v27, v27
  v_add_f32 v24, 1.0, v24
  v_add_f32 v25, 1.0, v25
  v_add_f32 v26, 1.0, v26
  v_add_f32 v27, 1.0, v27
  v_rcp_f32 v24, v24
  v_rcp_f32 v25, v25
  v_rcp_f32 v26, v26
  v_rcp_f32 v27, v27
  v_mul_f32 v20, v20, v24
  v_mul_f32 v21, v21, v25
  v_mul_f32 v22, v22, v26
  v_mul_f32 v23, v23, v27
  v_cvt_pk_bf16_f32 v20, v20, v20
  v_cvt_pk_bf16_f32 v21, v21, v21
  v_cvt_pk_bf16_f32 v22, v22, v22
  v_cvt_pk_bf16_f32 v23, v23, v23
  v_and_b32 v48, v20, v16
  v_and_b32 v49, v20, v17
  v_and_b32 v50, v20, v18
  v_and_b32 v51, v20, v19
  s_waitcnt vmcnt(3)
  s_nop 0
  v_mfma_f32_16x16x32_bf16 v[64:67], v[48:51], v[32:35], 0
  v_and_b32 v52, v21, v16
  v_and_b32 v53, v21, v17
  v_and_b32 v54, v21, v18
  v_and_b32 v55, v21, v19
  s_waitcnt vmcnt(2)
  s_nop 0
  v_mfma_f32_16x16x32_bf16 v[64:67], v[52:55], v[36:39], v[64:67]
  v_and_b32 v56, v22, v16
  v_and_b32 v57, v22, v17
  v_and_b32 v58, v22, v18
  v_and_b32 v59, v22, v19
  s_waitcnt vmcnt(1)
  s_nop 0
  v_mfma_f32_16x16x32_bf16 v[64:67], v[56:59], v[40:43], v[64:67]
  v_and_b32 v60, v23, v16
  v_and_b32 v61, v23, v17
  v_and_b32 v62, v23, v18
  v_and_b32 v63, v23, v19
  s_waitcnt vmcnt(0)
  s_nop 0
  v_mfma_f32_16x16x32_bf16 v[64:67], v[60:63], v[44:47], v[64:67]
  s_mov_b32 exec_lo, 0x00FF00FF
  s_mov_b32 exec_hi, 0xFF00FF00
  s_nop 5
  ds_write2_b32 v12, v64, v65 offset0:0 offset1:20
  ds_write2_b32 v12, v66, v67 offset0:40 offset1:60
  s_mov_b64 exec, -1
  s_cmp_lg_u32 s49, 1
  s_cbranch_scc1 L_A_pt
  s_and_b32 s57, s2, 7
  s_bfe_u32 s58, s2, 0x30003
  s_lshr_b32 s66, s2, 6
  s_lshl_b32 s67, s57, 17
  s_lshl_b32 s52, s66, 11
  s_add_u32 s67, s67, s52
  s_lshl_b32 s52, s58, 8
  s_add_u32 s67, s67, s52
  s_lshl_b32 s52, s58, 8
  s_add_u32 s67, s67, 3211264
  s_and_b32 s68, s57, 3
  s_lshl_b32 s68, s68, 11
  s_add_u32 s68, s68, s52
  s_lshr_b32 s52, s57, 2
  s_lshl_b32 s52, s52, 14
  s_add_u32 s68, s68, s52
  s_add_u32 s68, s68, 65536
  s_and_b32 s53, s2, 3
  s_lshl_b32 s52, s53, 11
  s_bfe_u32 s53, s2, 0x40002
  s_lshl_b32 s53, s53, 14
  s_add_u32 s52, s52, s53
  s_add_u32 s52, s52, 1048576
  s_cmp_lt_u32 s2, 64
  v_lshlrev_b32 v15, 7, v2
  v_lshl_add_u32 v15, v3, 13, v15
  s_mov_b64 exec, 3
  buffer_load_dword v163, v15, s[32:35], s67 offen
  s_mov_b64 exec, 0x30003
  buffer_load_dword v164, v15, s[32:35], s68 offen
  s_mov_b32 exec_lo, -1
  s_cbranch_scc1 L_A_pt2
  buffer_load_dword v165, v15, s[32:35], s52 offen
  s_mov_b64 exec, -1
  s_branch L_A_pt
L_A_pt2:
  s_mov_b64 exec, -1
L_A_pt:
  v_lshlrev_b32 v15, 4, v1
  s_waitcnt lgkmcnt(0)
  s_barrier
  s_cmp_lg_u32 s69, 0
  s_cbranch_scc1 L_phase2
  ds_read_b128 v[32:35], v13 offset:0
  ds_read_b128 v[36:39], v13 offset:16
  s_waitcnt lgkmcnt(0)
  v_pk_add_f32 v[32:33], v[32:33], v[36:37]
  v_pk_add_f32 v[34:35], v[34:35], v[38:39]
  v_pk_add_f32 v[32:33], v[32:33], v[34:35]
  v_add_f32 v20, v32, v33
  v_mov_b32 v21, v20
  s_nop 1
  v_permlane16_swap_b32 v20, v21
  v_mov_b32 v22, v20
  v_mov_b32 v23, v21
  s_nop 0
  v_permlane32_swap_b32 v20, v22
  v_permlane32_swap_b32 v21, v23
  v_perm_b32 v28, v20, v23, s61
  v_perm_b32 v29, v21, v23, s62
  v_perm_b32 v30, v22, v23, s63
  s_mov_b64 exec, 0xffff
  buffer_store_dwordx4 v[28:31], v15, s[32:35], s56 offen sc1
  s_mov_b64 exec, -1
  s_branch L_phase2
L_notask:
  s_waitcnt lgkmcnt(0)
  s_load_dword s55, s[30:31], 0
  s_mov_b32 s32, s30
  s_mov_b32 s33, s31
  s_waitcnt lgkmcnt(0)
  s_mul_i32 s48, s55, 0x9E3779B1
  s_add_u32 s48, s48, 0x7F4A7C15
  s_cmp_lg_u32 s49, 1
  s_cbranch_scc1 L_A_ptb
  s_and_b32 s57, s2, 7
  s_bfe_u32 s58, s2, 0x30003
  s_lshr_b32 s66, s2, 6
  s_lshl_b32 s67, s57, 17
  s_lshl_b32 s52, s66, 11
  s_add_u32 s67, s67, s52
  s_lshl_b32 s52, s58, 8
  s_add_u32 s67, s67, s52
  s_lshl_b32 s52, s58, 8
  s_add_u32 s67, s67, 3211264
  s_and_b32 s68, s57, 3
  s_lshl_b32 s68, s68, 11
  s_add_u32 s68, s68, s52
  s_lshr_b32 s52, s57, 2
  s_lshl_b32 s52, s52, 14
  s_add_u32 s68, s68, s52
  s_add_u32 s68, s68, 65536
  s_and_b32 s53, s2, 3
  s_lshl_b32 s52, s53, 11
  s_bfe_u32 s53, s2, 0x40002
  s_lshl_b32 s53, s53, 14
  s_add_u32 s52, s52, s53
  s_add_u32 s52, s52, 1048576
  s_cmp_lt_u32 s2, 64
  v_lshlrev_b32 v15, 7, v2
  v_lshl_add_u32 v15, v3, 13, v15
  s_mov_b64 exec, 3
  buffer_load_dword v163, v15, s[32:35], s67 offen
  s_mov_b64 exec, 0x30003
  buffer_load_dword v164, v15, s[32:35], s68 offen
  s_mov_b32 exec_lo, -1
  s_cbranch_scc1 L_A_pt2b
  buffer_load_dword v165, v15, s[32:35], s52 offen
  s_mov_b64 exec, -1
  s_branch L_A_ptb
L_A_pt2b:
  s_mov_b64 exec, -1
L_A_ptb:
  v_lshlrev_b32 v15, 4, v1
  s_barrier
  s_branch L_phase2
L_B_body:
  v_mul_u32_u24 v12, 672, v6
  v_lshl_add_u32 v12, v5, 2, v12
  s_lshl_b32 s52, s69, 3
  s_add_u32 s52, s52, 5376
  v_add_u32 v12, s52, v12
  v_lshl_add_u32 v13, v2, 2, v3
  v_mul_u32_u24 v13, 80, v13
  v_lshrrev_b32 v4, 1, v2
  v_mad_u32_u24 v13, v4, 32, v13
  s_lshl_b32 s52, s68, 8
  v_lshl_add_u32 v10, v2, 4, s52
  v_lshl_add_u32 v10, v3, 18, v10
  v_add_u32 v11, 2048, v10
  v_lshlrev_b32 v15, 4, v1
  s_lshl_b32 s67, s57, 17
  s_lshl_b32 s52, s66, 11
  s_add_u32 s67, s67, s52
  s_lshl_b32 s52, s58, 8
  s_add_u32 s67, s67, s52
  s_lshl_b32 s52, s58, 8
  s_add_u32 s67, s67, 2162688
  s_waitcnt vmcnt(8)
  v_lshlrev_b32 v64, 16, v20
  v_and_b32 v65, s60, v20
  v_lshlrev_b32 v66, 16, v21
  v_and_b32 v67, s60, v21
  v_lshlrev_b32 v68, 16, v22
  v_and_b32 v69, s60, v22
  v_lshlrev_b32 v70, 16, v23
  v_and_b32 v71, s60, v23
  v_add_f32 v24, v64, v65
  v_add_f32 v24, v24, v66
  v_add_f32 v24, v24, v67
  v_add_f32 v24, v24, v68
  v_add_f32 v24, v24, v69
  v_add_f32 v24, v24, v70
  v_add_f32 v24, v24, v71
  s_nop 1
  v_add_f32_dpp v24, v24, v24 quad_perm:[1,0,3,2] row_mask:0xf bank_mask:0xf
  s_nop 1
  v_add_f32_dpp v24, v24, v24 quad_perm:[2,3,0,1] row_mask:0xf bank_mask:0xf
  s_nop 1
  v_add_f32_dpp v24, v24, v24 row_half_mirror row_mask:0xf bank_mask:0xf
  s_nop 1
  v_add_f32_dpp v24, v24, v24 row_mirror row_mask:0xf bank_mask:0xf
  v_mov_b32 v25, v24
  s_nop 1
  v_permlane16_swap_b32 v24, v25
  v_add_f32 v24, v24, v25
  v_mov_b32 v25, v24
  s_nop 1
  v_permlane32_swap_b32 v24, v25
  v_add_f32 v24, v24, v25
  v_mul_f32 v24, 0x3b000000, v24
  v_sub_f32 v64, v64, v24
  v_sub_f32 v65, v65, v24
  v_sub_f32 v66, v66, v24
  v_sub_f32 v67, v67, v24
  v_sub_f32 v68, v68, v24
  v_sub_f32 v69, v69, v24
  v_sub_f32 v70, v70, v24
  v_sub_f32 v71, v71, v24
  v_mul_f32 v26, v64, v64
  v_fmac_f32 v26, v65, v65
  v_fmac_f32 v26, v66, v66
  v_fmac_f32 v26, v67, v67
  v_fmac_f32 v26, v68, v68
  v_fmac_f32 v26, v69, v69
  v_fmac_f32 v26, v70, v70
  v_fmac_f32 v26, v71, v71
  s_nop 1
  v_add_f32_dpp v26, v26, v26 quad_perm:[1,0,3,2] row_mask:0xf bank_mask:0xf
  s_nop 1
  v_add_f32_dpp v26, v26, v26 quad_perm:[2,3,0,1] row_mask:0xf bank_mask:0xf
  s_nop 1
  v_add_f32_dpp v26, v26, v26 row_half_mirror row_mask:0xf bank_mask:0xf
  s_nop 1
  v_add_f32_dpp v26, v26, v26 row_mirror row_mask:0xf bank_mask:0xf
  v_mov_b32 v25, v26
  s_nop 1
  v_permlane16_swap_b32 v26, v25
  v_add_f32 v26, v26, v25
  v_mov_b32 v25, v26
  s_nop 1
  v_permlane32_swap_b32 v26, v25
  v_add_f32 v26, v26, v25
  v_mul_f32 v26, 0x3b000000, v26
  v_cvt_pk_bf16_f32 v24, v24, v24
  v_and_b32 v24, s60, v24
  v_cvt_pk_bf16_f32 v26, v26, v26
  v_and_b32 v26, s60, v26
  v_add_f32 v26, 0x3727c5ac, v26
  v_cvt_pk_bf16_f32 v26, v26, v26
  v_and_b32 v26, s60, v26
  v_sqrt_f32 v26, v26
  s_nop 0
  v_cvt_pk_bf16_f32 v26, v26, v26
  v_and_b32 v26, s60, v26
  v_rcp_f32 v25, v26
  v_lshlrev_b32 v19, 16, v19
  v_sub_f32 v19, v19, v24
  v_cvt_pk_bf16_f32 v19, v19, v19
  v_and_b32 v19, s60, v19
  v_mul_f32 v27, v19, v25
  v_fma_f32 v19, -v27, v26, v19
  v_fma_f32 v19, v19, v25, v27
  v_cvt_pk_bf16_f32 v19, v19, v19
  v_and_b32 v19, s60, v19
  s_waitcnt lgkmcnt(0)
  s_mul_i32 s48, s55, 0x9E3779B1
  s_add_u32 s48, s48, 0x7F4A7C15
  v_mov_b32 v131, s48
  s_mov_b32 s59, 2097152
  s_add_u32 s58, s59, 131072
  s_setprio 2
  s_waitcnt vmcnt(6)
  v_perm_b32 v64, v36, v32, s50
  v_perm_b32 v68, v36, v32, s51
  v_perm_b32 v72, v37, v33, s50
  v_perm_b32 v76, v37, v33, s51
  v_perm_b32 v80, v38, v34, s50
  v_perm_b32 v84, v38, v34, s51
  v_perm_b32 v88, v39, v35, s50
  v_perm_b32 v92, v39, v35, s51
  s_waitcnt vmcnt(4)
  v_perm_b32 v65, v44, v40, s50
  v_perm_b32 v69, v44, v40, s51
  v_perm_b32 v73, v45, v41, s50
  v_perm_b32 v77, v45, v41, s51
  v_perm_b32 v81, v46, v42, s50
  v_perm_b32 v85, v46, v42, s51
  v_perm_b32 v89, v47, v43, s50
  v_perm_b32 v93, v47, v43, s51
  s_waitcnt vmcnt(2)
  v_perm_b32 v66, v52, v48, s50
  v_perm_b32 v70, v52, v48, s51
  v_perm_b32 v74, v53, v49, s50
  v_perm_b32 v78, v53, v49, s51
  v_perm_b32 v82, v54, v50, s50
  v_perm_b32 v86, v54, v50, s51
  v_perm_b32 v90, v55, v51, s50
  v_perm_b32 v94, v55, v51, s51
  s_waitcnt vmcnt(0)
  v_perm_b32 v67, v60, v56, s50
  v_perm_b32 v71, v60, v56, s51
  v_perm_b32 v75, v61, v57, s50
  v_perm_b32 v79, v61, v57, s51
  v_perm_b32 v83, v62, v58, s50
  v_perm_b32 v87, v62, v58, s51
  v_perm_b32 v91, v63, v59, s50
  v_perm_b32 v95, v63, v59, s51
  buffer_load_dwordx4 v[96:99], v10, s[32:35], s59 offen sc1
  buffer_load_dwordx4 v[100:103], v11, s[32:35], s59 offen sc1
  buffer_load_dwordx4 v[104:107], v10, s[32:35], s58 offen sc1
  buffer_load_dwordx4 v[108:111], v11, s[32:35], s58 offen sc1
  s_waitcnt vmcnt(0)
  v_cmp_ne_u32 vcc, s48, v99
  v_cmp_ne_u32 s[52:53], s48, v103
  s_nop 0
  s_or_b64 vcc, vcc, s[52:53]
  v_cmp_ne_u32 s[52:53], s48, v107
  s_nop 0
  s_or_b64 vcc, vcc, s[52:53]
  v_cmp_ne_u32 s[52:53], s48, v111
  s_nop 0
  s_or_b64 vcc, vcc, s[52:53]
  s_cbranch_vccz L_B_got
  s_mov_b64 exec, vcc
L_poll_1:
  buffer_load_dwordx4 v[96:99], v10, s[32:35], s59 offen offset:0 sc1
  buffer_load_dwordx4 v[100:103], v11, s[32:35], s59 offen offset:0 sc1
  buffer_load_dwordx4 v[104:107], v10, s[32:35], s58 offen offset:0 sc1
  buffer_load_dwordx4 v[108:111], v11, s[32:35], s58 offen offset:0 sc1
  s_sub_u32 s54, s54, 1
  s_cbranch_scc1 L_end
  s_waitcnt vmcnt(0)
  v_cmp_ne_u32 vcc, s48, v99
  v_cmp_ne_u32 s[52:53], s48, v103
  s_nop 0
  s_or_b64 vcc, vcc, s[52:53]
  v_cmp_ne_u32 s[52:53], s48, v107
  s_nop 0
  s_or_b64 vcc, vcc, s[52:53]
  v_cmp_ne_u32 s[52:53], s48, v111
  s_nop 0
  s_or_b64 vcc, vcc, s[52:53]
  s_mov_b64 exec, vcc
  s_cbranch_vccnz L_poll_1
  s_mov_b64 exec, -1
L_B_got:
  v_perm_b32 v99, v97, v96, s64
  v_perm_b32 v99, v98, v99, s65
  v_perm_b32 v103, v101, v100, s64
  v_perm_b32 v103, v102, v103, s65
  v_perm_b32 v107, v105, v104, s64
  v_perm_b32 v107, v106, v107, s65
  v_perm_b32 v111, v109, v108, s64
  v_perm_b32 v111, v110, v111, s65
  v_pk_add_f32 v[96:97], v[96:97], v[104:105]
  v_pk_add_f32 v[98:99], v[98:99], v[106:107]
  v_pk_add_f32 v[100:101], v[100:101], v[108:109]
  v_pk_add_f32 v[102:103], v[102:103], v[110:111]
  v_permlane32_swap_b32 v96, v98
  v_permlane32_swap_b32 v97, v99
  v_permlane32_swap_b32 v100, v102
  v_permlane32_swap_b32 v101, v103
  v_pk_add_f32 v[96:97], v[96:97], v[98:99]
  v_pk_add_f32 v[100:101], v[100:101], v[102:103]
  s_nop 0
  v_permlane16_swap_b32 v96, v97
  v_permlane16_swap_b32 v100, v101
  v_add_f32 v20, v96, v97
  v_add_f32 v21, v100, v101
  v_cvt_pk_bf16_f32 v22, v20, v21
  v_lshlrev_b32 v20, 16, v22
  v_and_b32 v21, s60, v22
  v_add_f32 v21, 1.0, v21
  v_cvt_pk_bf16_f32 v21, v21, v21
  v_and_b32 v21, s60, v21
  v_mul_f32 v21, v21, v19
  v_cvt_pk_bf16_f32 v21, v21, v21
  v_and_b32 v21, s60, v21
  v_add_f32 v21, v21, v20
  s_nop 1
  v_mov_b32_dpp v22, v21 quad_perm:[1,1,3,3] row_mask:0xf bank_mask:0xf
  v_cvt_pk_bf16_f32 v28, v21, v22
  s_nop 1
  v_mov_b32_dpp v29, v28 row_shl:2 row_mask:0xf bank_mask:0xf
  v_mov_b32_dpp v30, v28 row_shl:4 row_mask:0xf bank_mask:0xf
  v_mov_b32_dpp v31, v28 row_shl:6 row_mask:0xf bank_mask:0xf
  s_nop 1
  v_mfma_f32_16x16x32_bf16 v[96:99], v[28:31], v[64:67], 0
  v_mfma_f32_16x16x32_bf16 v[100:103], v[28:31], v[68:71], 0
  v_mfma_f32_16x16x32_bf16 v[104:107], v[28:31], v[72:75], 0
  v_mfma_f32_16x16x32_bf16 v[108:111], v[28:31], v[76:79], 0
  v_mfma_f32_16x16x32_bf16 v[112:115], v[28:31], v[80:83], 0
  v_mfma_f32_16x16x32_bf16 v[116:119], v[28:31], v[84:87], 0
  v_mfma_f32_16x16x32_bf16 v[120:123], v[28:31], v[88:91], 0
  v_mfma_f32_16x16x32_bf16 v[124:127], v[28:31], v[92:95], 0
  s_mov_b32 exec_lo, 0xff
  s_mov_b32 exec_hi, 0xff00
  ds_write2_b32 v12, v96, v100 offset0:0 offset1:20
  s_nop 0
  ds_write2_b32 v12, v104, v108 offset0:40 offset1:60
  s_nop 0
  ds_write2_b32 v12, v112, v116 offset0:80 offset1:100
  s_nop 0
  ds_write2_b32 v12, v120, v124 offset0:120 offset1:140
  s_mov_b64 exec, -1
  s_waitcnt lgkmcnt(0)
  s_barrier
  s_cmp_lg_u32 s49, 4
  s_cbranch_scc1 L_phase2
  ds_read_b128 v[32:35], v13 offset:5376
  ds_read_b128 v[36:39], v13 offset:5392
  s_waitcnt lgkmcnt(0)
  v_pk_add_f32 v[32:33], v[32:33], v[36:37]
  v_pk_add_f32 v[34:35], v[34:35], v[38:39]
  v_pk_add_f32 v[32:33], v[32:33], v[34:35]
  v_add_f32 v20, v32, v33
  v_mov_b32 v21, v20
  s_nop 1
  v_permlane16_swap_b32 v20, v21
  v_mov_b32 v22, v20
  v_mov_b32 v23, v21
  s_nop 0
  v_permlane32_swap_b32 v20, v22
  v_permlane32_swap_b32 v21, v23
  v_perm_b32 v128, v20, v23, s61
  v_perm_b32 v129, v21, v23, s62
  v_perm_b32 v130, v22, v23, s63
  s_mov_b64 exec, 0xffff
  s_add_u32 s52, s67, 1048576
  buffer_store_dwordx4 v[128:131], v15, s[32:35], s52 offen
  buffer_store_dwordx4 v[128:131], v15, s[32:35], s67 offen sc1
  s_mov_b64 exec, -1
L_phase2:
  s_setprio 0
  s_mov_b32 s99, 0
  s_barrier
  s_cmp_lt_u32 s2, 64
  s_cbranch_scc1 L_D
  s_and_b32 s52, s2, 0x30
  s_lshr_b32 s53, s52, 4
  s_mul_i32 s53, s53, 1
  s_add_u32 s53, s53, s2
  s_and_b32 s53, s53, 7
  s_lshl_b32 s53, s53, 1
  s_or_b32 s98, s52, s53
  s_bfe_u32 s53, s2, 0x10003
  s_or_b32 s98, s98, s53
  s_lshl_b32 s53, s53, 2
  s_xor_b32 s3, s49, s53
  s_lshl_b32 s52, s3, 4
  v_add_u32 v176, s52, v2
  v_lshlrev_b32 v177, 4, v176
  v_lshl_add_u32 v178, v3, 18, v177
  v_and_b32 v17, 1, v3
  v_lshl_add_u32 v177, v17, 12, v177
  v_lshrrev_b32 v17, 1, v3
  v_lshl_add_u32 v177, v17, 14, v177
  v_lshl_add_u32 v17, v176, 2, v3
  v_lshlrev_b32 v18, 1, v17
  s_mov_b32 s44, s4
  s_mov_b32 s45, s5
  s_mov_b32 s46, 1024
  s_mov_b32 s47, 0x20000
  buffer_load_ushort v179, v18, s[44:47], 0 offen
  s_cmp_lt_u32 s49, 4
  s_cbranch_scc1 L_F_gb1
  s_mov_b32 s44, s12
  s_mov_b32 s45, s13
  s_mov_b32 s46, 4194304
  s_mov_b32 s47, 0x20000
  s_cmp_lg_u32 s49, 4
  s_cbranch_scc1 L_F_c1
  s_and_b32 s57, s2, 7
  s_bfe_u32 s58, s2, 0x30003
  v_lshrrev_b32 v10, 1, v1
  v_lshlrev_b32 v10, 2, v10
  v_and_b32 v11, 1, v1
  v_add3_u32 v10, v10, v11, 2
  v_lshlrev_b32 v10, 10, v10
  s_mov_b32 exec_hi, 0
  s_lshl_b32 s52, s57, 19
  s_lshl_b32 s53, s58, 16
  s_add_u32 s52, s52, s53
  buffer_load_dword v166, v10, s[44:47], s52 offen offset:384
  s_mov_b64 exec, -1
  s_branch L_F_c1
L_F_gb1:
L_F_c1:
  v_lshl_add_u32 v7, v5, 5, v3
  s_lshl_b32 s52, s3, 6
  v_add_u32 v7, s52, v7
  v_mul_u32_u24 v7, 3584, v7
  v_and_b32 v9, 3, v2
  v_lshl_add_u32 v7, v9, 4, v7
  s_min_u32 s53, s98, 55
  s_lshl_b32 s53, s53, 6
  v_add_u32 v7, s53, v7
  v_and_b32 v9, 4, v2
  v_cmp_eq_u32 vcc, 0, v9
  v_mov_b32 v8, s18
  v_mov_b32 v9, s16
  v_cndmask_b32 v180, v8, v9, vcc
  v_mov_b32 v8, s19
  v_mov_b32 v9, s17
  v_cndmask_b32 v181, v8, v9, vcc
  v_add_co_u32 v180, vcc, v180, v7
  s_nop 1
  v_addc_co_u32 v181, vcc, 0, v181, vcc
  s_mov_b32 s59, 2131968
  s_cmp_ge_u32 s98, 56
  s_cbranch_scc1 L_spare
  s_mov_b32 s56, s98
  s_cmp_lt_u32 s49, 4
  s_cbranch_scc1 L_F_gb2
  global_load_dwordx4 v[32:35], v[180:181], off
  v_add_co_u32 v180, vcc, 14336, v180
  s_nop 1
  v_addc_co_u32 v181, vcc, 0, v181, vcc
  s_bfe_u32 s52, s98, 0x20001
  s_cmp_eq_u32 s52, 3
  s_cbranch_scc1 L_F_nopause
  s_waitcnt vmcnt(0)
  global_load_dwordx4 v[36:39], v[180:181], off
  v_add_co_u32 v180, vcc, 14336, v180
  s_nop 1
  v_addc_co_u32 v181, vcc, 0, v181, vcc
  s_waitcnt vmcnt(0)
  s_branch L_F_np2
L_F_nopause:
  global_load_dwordx4 v[36:39], v[180:181], off
  v_add_co_u32 v180, vcc, 14336, v180
  s_nop 1
  v_addc_co_u32 v181, vcc, 0, v181, vcc
L_F_np2:
  global_load_dwordx4 v[40:43], v[180:181], off
  v_add_co_u32 v180, vcc, 14336, v180
  s_nop 1
  v_addc_co_u32 v181, vcc, 0, v181, vcc
  global_load_dwordx4 v[44:47], v[180:181], off
  v_add_co_u32 v180, vcc, 14336, v180
  s_nop 1
  v_addc_co_u32 v181, vcc, 0, v181, vcc
  global_load_dwordx4 v[48:51], v[180:181], off
  v_add_co_u32 v180, vcc, 14336, v180
  s_nop 1
  v_addc_co_u32 v181, vcc, 0, v181, vcc
  global_load_dwordx4 v[52:55], v[180:181], off
  v_add_co_u32 v180, vcc, 14336, v180
  s_nop 1
  v_addc_co_u32 v181, vcc, 0, v181, vcc
  global_load_dwordx4 v[56:59], v[180:181], off
  v_add_co_u32 v180, vcc, 14336, v180
  s_nop 1
  v_addc_co_u32 v181, vcc, 0, v181, vcc
  global_load_dwordx4 v[60:63], v[180:181], off
  s_mov_b32 s59, 2129920
  s_mov_b32 s57, 2134016
  buffer_load_dwordx4 v[168:171], v178, s[32:35], s59 offen offset:2048 sc1
  buffer_load_dwordx4 v[172:175], v178, s[32:35], s57 offen sc1
  s_barrier
  s_lshl_b32 s52, s2, 1
  s_bfe_u32 s53, s49, 0x10001
  s_add_u32 s52, s52, s53
  s_and_b32 s53, s52, 63
  s_lshl_b32 s53, s53, 7
  s_lshr_b32 s52, s52, 6
  s_lshl_b32 s52, s52, 14
  s_add_u32 s52, s52, s53
  s_add_u32 s52, s52, 1310720
  s_add_u32 s100, s30, s52
  s_addc_u32 s101, s31, 0
  s_mov_b32 s28, 0x7fffffff
  s_mov_b32 s29, 0x7fffffff
  s_memtime s[44:45]
  s_waitcnt lgkmcnt(0)
  s_load_dword s52, s[100:101], 0 glc
  s_waitcnt lgkmcnt(0)
  s_memtime s[46:47]
  s_waitcnt lgkmcnt(0)
  s_sub_u32 s53, s46, s44
  s_min_u32 s28, s28, s53
  s_memtime s[44:45]
  s_waitcnt lgkmcnt(0)
  s_load_dword s52, s[100:101], 8192 glc
  s_waitcnt lgkmcnt(0)
  s_memtime s[46:47]
  s_waitcnt lgkmcnt(0)
  s_sub_u32 s53, s46, s44
  s_min_u32 s29, s29, s53
  s_cmp_gt_u32 s28, s29
  s_lshl_b32 s52, s49, 3
  v_mov_b32 v25, s52
  v_mov_b32 v26, s28
  v_mov_b32 v27, s29
  ds_write_b64 v25, v[26:27] offset:16416
  s_waitcnt vmcnt(0)
  v_cmp_ne_u32 vcc, s48, v171
  v_cmp_ne_u32 s[52:53], s48, v175
  s_nop 0
  s_or_b64 vcc, vcc, s[52:53]
  s_cbranch_vccz L_ffn_gotm
  s_mov_b64 exec, vcc
  s_branch L_ffn_pollm
L_F_gb2:
  s_lshl_b32 s52, s2, 1
  s_bfe_u32 s53, s49, 0x10001
  s_add_u32 s52, s52, s53
  s_and_b32 s53, s52, 63
  s_lshl_b32 s53, s53, 7
  s_lshr_b32 s52, s52, 6
  s_lshl_b32 s52, s52, 14
  s_add_u32 s52, s52, s53
  s_add_u32 s52, s52, 1310720
  s_add_u32 s100, s30, s52
  s_addc_u32 s101, s31, 0
  s_mov_b32 s28, 0x7fffffff
  s_mov_b32 s29, 0x7fffffff
  s_memtime s[44:45]
  s_waitcnt lgkmcnt(0)
  s_load_dword s52, s[100:101], 0 glc
  s_waitcnt lgkmcnt(0)
  s_memtime s[46:47]
  s_waitcnt lgkmcnt(0)
  s_sub_u32 s53, s46, s44
  s_min_u32 s28, s28, s53
  s_memtime s[44:45]
  s_waitcnt lgkmcnt(0)
  s_load_dword s52, s[100:101], 8192 glc
  s_waitcnt lgkmcnt(0)
  s_memtime s[46:47]
  s_waitcnt lgkmcnt(0)
  s_sub_u32 s53, s46, s44
  s_min_u32 s29, s29, s53
  s_cmp_gt_u32 s28, s29
  s_lshl_b32 s52, s49, 3
  v_mov_b32 v25, s52
  v_mov_b32 v26, s28
  v_mov_b32 v27, s29
  ds_write_b64 v25, v[26:27] offset:16416
  s_barrier
  s_mov_b32 s59, 2129920
  s_mov_b32 s57, 2134016
  buffer_load_dwordx4 v[168:171], v178, s[32:35], s59 offen offset:2048 sc1
  buffer_load_dwordx4 v[172:175], v178, s[32:35], s57 offen sc1
  global_load_dwordx4 v[32:35], v[180:181], off
  v_add_co_u32 v180, vcc, 14336, v180
  s_nop 1
  v_addc_co_u32 v181, vcc, 0, v181, vcc
  global_load_dwordx4 v[36:39], v[180:181], off
  v_add_co_u32 v180, vcc, 14336, v180
  s_nop 1
  v_addc_co_u32 v181, vcc, 0, v181, vcc
  global_load_dwordx4 v[40:43], v[180:181], off
  v_add_co_u32 v180, vcc, 14336, v180
  s_nop 1
  v_addc_co_u32 v181, vcc, 0, v181, vcc
  global_load_dwordx4 v[44:47], v[180:181], off
  v_add_co_u32 v180, vcc, 14336, v180
  s_nop 1
  v_addc_co_u32 v181, vcc, 0, v181, vcc
  global_load_dwordx4 v[48:51], v[180:181], off
  v_add_co_u32 v180, vcc, 14336, v180
  s_nop 1
  v_addc_co_u32 v181, vcc, 0, v181, vcc
  global_load_dwordx4 v[52:55], v[180:181], off
  v_add_co_u32 v180, vcc, 14336, v180
  s_nop 1
  v_addc_co_u32 v181, vcc, 0, v181, vcc
  global_load_dwordx4 v[56:59], v[180:181], off
  v_add_co_u32 v180, vcc, 14336, v180
  s_nop 1
  v_addc_co_u32 v181, vcc, 0, v181, vcc
  global_load_dwordx4 v[60:63], v[180:181], off
  s_waitcnt vmcnt(8)
  v_cmp_ne_u32 vcc, s48, v171
  v_cmp_ne_u32 s[52:53], s48, v175
  s_nop 0
  s_or_b64 vcc, vcc, s[52:53]
  s_cbranch_vccz L_ffn_gotm
  s_mov_b64 exec, vcc
L_ffn_pollm:
L_poll_4:
  s_sleep 8
  buffer_load_dwordx4 v[168:171], v178, s[32:35], s59 offen offset:2048 sc1
  buffer_load_dwordx4 v[172:175], v178, s[32:35], s57 offen offset:0 sc1
  s_sub_u32 s54, s54, 1
  s_cbranch_scc1 L_end
  s_waitcnt vmcnt(0)
  v_cmp_ne_u32 vcc, s48, v171
  v_cmp_ne_u32 s[52:53], s48, v175
  s_nop 0
  s_or_b64 vcc, vcc, s[52:53]
  s_mov_b64 exec, vcc
  s_cbranch_vccnz L_poll_4
  s_mov_b64 exec, -1
L_ffn_gotm:
  v_perm_b32 v171, v169, v168, s64
  v_perm_b32 v171, v170, v171, s65
  v_permlane32_swap_b32 v168, v170
  s_nop 0
  v_permlane32_swap_b32 v169, v171
  v_add_f32 v168, v168, v170
  v_add_f32 v169, v169, v171
  s_nop 1
  v_permlane16_swap_b32 v168, v169
  v_add_f32 v161, v168, v169
  v_perm_b32 v175, v173, v172, s64
  v_perm_b32 v175, v174, v175, s65
  v_permlane32_swap_b32 v172, v174
  s_nop 0
  v_permlane32_swap_b32 v173, v175
  v_add_f32 v172, v172, v174
  v_add_f32 v173, v173, v175
  s_nop 1
  v_permlane16_swap_b32 v172, v173
  v_add_f32 v162, v172, v173
  v_cvt_pk_bf16_f32 v25, v161, v162
  v_lshlrev_b32 v161, 16, v25
  v_and_b32 v162, s60, v25
  v_add_f32 v162, 1.0, v162
  v_cvt_pk_bf16_f32 v162, v162, v162
  v_and_b32 v162, s60, v162
  s_nop 1
  v_mov_b32_dpp v25, v162 quad_perm:[1,1,3,3] row_mask:0xf bank_mask:0xf
  v_cvt_pk_bf16_f32 v168, v162, v25
  s_nop 1
  v_mov_b32_dpp v169, v168 row_shl:2 row_mask:0xf bank_mask:0xf
  v_mov_b32_dpp v170, v168 row_shl:4 row_mask:0xf bank_mask:0xf
  v_mov_b32_dpp v171, v168 row_shl:6 row_mask:0xf bank_mask:0xf
  v_mov_b32_dpp v25, v161 quad_perm:[0,0,2,2] row_mask:0xf bank_mask:0xf
  v_cvt_pk_bf16_f32 v172, v25, v161
  s_nop 1
  v_mov_b32_dpp v173, v172 row_shl:2 row_mask:0xf bank_mask:0xf
  v_mov_b32_dpp v174, v172 row_shl:4 row_mask:0xf bank_mask:0xf
  v_mov_b32_dpp v175, v172 row_shl:6 row_mask:0xf bank_mask:0xf
  v_and_b32 v25, 1, v1
  v_cmp_eq_u32 vcc, 1, v25
  s_nop 1
  v_cndmask_b32 v168, v168, v172, vcc
  v_cndmask_b32 v169, v169, v173, vcc
  v_cndmask_b32 v170, v170, v174, vcc
  v_cndmask_b32 v171, v171, v175, vcc
  s_cmp_ge_u32 s49, 4
  s_cbranch_scc1 L_ffn_join
  s_mov_b32 s40, s20
  s_mov_b32 s41, s21
  s_mov_b32 s42, 1835008
  s_mov_b32 s43, 0x20000
  s_lshl_b32 s53, s56, 15
  s_lshl_b32 s52, s69, 8
  s_add_u32 s53, s53, s52
  v_lshlrev_b32 v14, 13, v3
  v_lshl_add_u32 v14, v2, 4, v14
  v_add_u32 v14, s53, v14
  buffer_load_dwordx4 v[96:99], v14, s[40:43], 0 offen offset:0 nt
  buffer_load_dwordx4 v[100:103], v14, s[40:43], 0 offen offset:1024 nt
  buffer_load_dwordx4 v[104:107], v14, s[40:43], 0 offen offset:2048 nt
  buffer_load_dwordx4 v[108:111], v14, s[40:43], 0 offen offset:3072 nt
  s_mov_b32 s52, 4096
  buffer_load_dwordx4 v[112:115], v14, s[40:43], s52 offen nt
  s_mov_b32 s52, 5120
  buffer_load_dwordx4 v[116:119], v14, s[40:43], s52 offen nt
  s_mov_b32 s52, 6144
  buffer_load_dwordx4 v[120:123], v14, s[40:43], s52 offen nt
  s_mov_b32 s52, 7168
  buffer_load_dwordx4 v[124:127], v14, s[40:43], s52 offen nt
L_ffn_join:
  v_lshlrev_b32 v19, 16, v179
  v_mul_f32 v160, v19, v162
  v_mov_b32 v20, v177
  v_mul_u32_u24 v12, 672, v6
  v_lshl_add_u32 v12, v5, 2, v12
  s_lshl_b32 s52, s49, 3
  v_add_u32 v12, s52, v12
  v_add_u32 v13, 5376, v12
  v_add_u32 v22, 10752, v12
  v_lshrrev_b32 v23, 5, v1
  v_lshl_add_u32 v23, v23, 2, s52
  v_mov_b32 v24, 0
  v_lshlrev_b32 v14, 5, v5
  v_lshl_add_u32 v14, v3, 3, v14
  v_add_u32 v14, v14, v6
  v_mul_u32_u24 v14, 80, v14
  v_lshl_add_u32 v4, v5, 2, v3
  v_mad_u32_u24 v14, v4, 32, v14
  s_and_b32 s52, s98, 3
  s_lshl_b32 s52, s52, 11
  s_lshl_b32 s53, s69, 9
  s_add_u32 s66, s52, s53
  s_lshr_b32 s52, s98, 2
  s_lshl_b32 s52, s52, 14
  s_add_u32 s66, s66, s52
  s_add_u32 s66, s66, 1048576
  v_and_b32 v15, 31, v1
  v_lshlrev_b32 v15, 4, v15
  v_lshrrev_b32 v16, 5, v1
  v_lshl_add_u32 v15, v16, 13, v15
  v_and_b32 v16, 16, v1
  v_mov_b32 v10, 0xc0135761
  v_mov_b32 v11, 0xbdd2d3e8
  v_mov_b32 v7, 0x3727c5ac
  s_mov_b32 s67, 0x3b000000
  v_mov_b32 v167, s48
  s_add_u32 s59, s99, 65536
  s_lshr_b32 s68, s49, 2
  s_xor_b32 s68, s68, 1
  s_waitcnt vmcnt(8)
  v_perm_b32 v64, v36, v32, s50
  v_perm_b32 v68, v36, v32, s51
  v_perm_b32 v72, v37, v33, s50
  v_perm_b32 v76, v37, v33, s51
  v_perm_b32 v80, v38, v34, s50
  v_perm_b32 v84, v38, v34, s51
  v_perm_b32 v88, v39, v35, s50
  v_perm_b32 v92, v39, v35, s51
  v_perm_b32 v65, v44, v40, s50
  v_perm_b32 v69, v44, v40, s51
  v_perm_b32 v73, v45, v41, s50
  v_perm_b32 v77, v45, v41, s51
  v_perm_b32 v81, v46, v42, s50
  v_perm_b32 v85, v46, v42, s51
  v_perm_b32 v89, v47, v43, s50
  v_perm_b32 v93, v47, v43, s51
  v_perm_b32 v66, v52, v48, s50
  v_perm_b32 v70, v52, v48, s51
  v_perm_b32 v74, v53, v49, s50
  v_perm_b32 v78, v53, v49, s51
  v_perm_b32 v82, v54, v50, s50
  v_perm_b32 v86, v54, v50, s51
  v_perm_b32 v90, v55, v51, s50
  v_perm_b32 v94, v55, v51, s51
  v_perm_b32 v67, v60, v56, s50
  v_perm_b32 v71, v60, v56, s51
  v_perm_b32 v75, v61, v57, s50
  v_perm_b32 v79, v61, v57, s51
  v_perm_b32 v83, v62, v58, s50
  v_perm_b32 v87, v62, v58, s51
  v_perm_b32 v91, v63, v59, s50
  v_perm_b32 v95, v63, v59, s51
  v_mfma_f32_16x16x32_bf16 v[184:187], v[168:171], v[64:67], 0
  v_mfma_f32_16x16x32_bf16 v[188:191], v[168:171], v[68:71], 0
  v_mfma_f32_16x16x32_bf16 v[192:195], v[168:171], v[72:75], 0
  v_mfma_f32_16x16x32_bf16 v[196:199], v[168:171], v[76:79], 0
  v_mfma_f32_16x16x32_bf16 v[200:203], v[168:171], v[80:83], 0
  v_mfma_f32_16x16x32_bf16 v[204:207], v[168:171], v[84:87], 0
  v_mfma_f32_16x16x32_bf16 v[208:211], v[168:171], v[88:91], 0
  v_mfma_f32_16x16x32_bf16 v[212:215], v[168:171], v[92:95], 0
  s_mov_b32 exec_lo, 0xff
  s_mov_b32 exec_hi, 0xff00
  ds_write2_b32 v12, v184, v188 offset0:0 offset1:20
  s_nop 0
  ds_write2_b32 v12, v192, v196 offset0:40 offset1:60
  s_nop 0
  ds_write2_b32 v12, v200, v204 offset0:80 offset1:100
  s_nop 0
  ds_write2_b32 v12, v208, v212 offset0:120 offset1:140
  s_mov_b64 exec, -1
  s_mov_b32 exec_lo, 0xff
  s_mov_b32 exec_hi, 0xff00
  ds_write2_b32 v13, v185, v189 offset0:0 offset1:20
  ds_write2_b32 v13, v193, v197 offset0:40 offset1:60
  ds_write2_b32 v13, v201, v205 offset0:80 offset1:100
  ds_write2_b32 v13, v209, v213 offset0:120 offset1:140
  s_mov_b64 exec, -1
  s_waitcnt lgkmcnt(0)
  s_barrier
  ds_read_b128 v[40:43], v24 offset:16416
  ds_read_b128 v[44:47], v24 offset:16432
  ds_read_b128 v[48:51], v24 offset:16448
  ds_read_b128 v[52:55], v24 offset:16464
  s_waitcnt lgkmcnt(0)
  v_min3_u32 v40, v40, v48, v50
  v_min3_u32 v41, v41, v49, v51
  v_min3_u32 v42, v42, v52, v54
  v_min3_u32 v43, v43, v53, v55
  v_min3_u32 v40, v40, v42, v44
  v_min3_u32 v41, v41, v43, v45
  v_min_u32 v40, v40, v46
  v_min_u32 v40, 490, v40
  v_min_u32 v41, v41, v47
  v_cmp_gt_u32 vcc, v40, v41
  s_nop 0
  s_cmp_lg_u64 vcc, 0
  s_cselect_b32 s59, 0x2000, 0
  s_add_u32 s59, s59, 65536
  buffer_load_dwordx4 v[32:35], v20, s[32:35], s59 offen sc1
  buffer_load_dwordx4 v[36:39], v20, s[32:35], s59 offen offset:2048 sc1
  s_cmp_eq_u32 s68, 0
  s_cbranch_scc1 L_ffn_nored
  ds_read_b128 v[184:187], v14 offset:5376
  ds_read_b128 v[188:191], v14 offset:5392
  ds_read_b128 v[192:195], v14 offset:5408
  ds_read_b128 v[196:199], v14 offset:5424
  ds_read_b128 v[40:43], v14 offset:0
  ds_read_b128 v[44:47], v14 offset:16
  ds_read_b128 v[48:51], v14 offset:32
  ds_read_b128 v[52:55], v14 offset:48
  s_waitcnt lgkmcnt(0)
  v_pk_add_f32 v[40:41], v[40:41], v[48:49]
  v_pk_add_f32 v[42:43], v[42:43], v[50:51]
  v_pk_add_f32 v[44:45], v[44:45], v[52:53]
  v_pk_add_f32 v[46:47], v[46:47], v[54:55]
  v_pk_add_f32 v[40:41], v[40:41], v[44:45]
  v_pk_add_f32 v[42:43], v[42:43], v[46:47]
  v_pk_add_f32 v[40:41], v[40:41], v[42:43]
  v_add_f32 v163, v40, v41
  v_pk_add_f32 v[184:185], v[184:185], v[192:193]
  v_pk_add_f32 v[186:187], v[186:187], v[194:195]
  v_pk_add_f32 v[188:189], v[188:189], v[196:197]
  v_pk_add_f32 v[190:191], v[190:191], v[198:199]
  v_pk_add_f32 v[184:185], v[184:185], v[188:189]
  v_pk_add_f32 v[186:187], v[186:187], v[190:191]
  v_pk_add_f32 v[184:185], v[184:185], v[186:187]
  v_add_f32 v161, v184, v185
  s_waitcnt vmcnt(8)
  v_perm_b32 v128, v100, v96, s50
  v_perm_b32 v132, v100, v96, s51
  v_perm_b32 v136, v101, v97, s50
  v_perm_b32 v140, v101, v97, s51
  v_perm_b32 v144, v102, v98, s50
  v_perm_b32 v148, v102, v98, s51
  v_perm_b32 v152, v103, v99, s50
  v_perm_b32 v156, v103, v99, s51
  s_waitcnt vmcnt(6)
  v_perm_b32 v129, v108, v104, s50
  v_perm_b32 v133, v108, v104, s51
  v_perm_b32 v137, v109, v105, s50
  v_perm_b32 v141, v109, v105, s51
  v_perm_b32 v145, v110, v106, s50
  v_perm_b32 v149, v110, v106, s51
  v_perm_b32 v153, v111, v107, s50
  v_perm_b32 v157, v111, v107, s51
  s_waitcnt vmcnt(4)
  v_perm_b32 v130, v116, v112, s50
  v_perm_b32 v134, v116, v112, s51
  v_perm_b32 v138, v117, v113, s50
  v_perm_b32 v142, v117, v113, s51
  v_perm_b32 v146, v118, v114, s50
  v_perm_b32 v150, v118, v114, s51
  v_perm_b32 v154, v119, v115, s50
  v_perm_b32 v158, v119, v115, s51
  s_waitcnt vmcnt(2)
  v_perm_b32 v131, v124, v120, s50
  v_perm_b32 v135, v124, v120, s51
  v_perm_b32 v139, v125, v121, s50
  v_perm_b32 v143, v125, v121, s51
  v_perm_b32 v147, v126, v122, s50
  v_perm_b32 v151, v126, v122, s51
  v_perm_b32 v155, v127, v123, s50
  v_perm_b32 v159, v127, v123, s51
L_ffn_nored:
  s_waitcnt vmcnt(0)
  v_cmp_ne_u32 vcc, s48, v35
  v_cmp_ne_u32 s[52:53], s48, v39
  s_nop 0
  s_or_b64 vcc, vcc, s[52:53]
  s_cbranch_vccz L_ffn_gota
  s_mov_b64 exec, vcc
L_poll_5:
  buffer_load_dwordx4 v[32:35], v20, s[32:35], s59 offen offset:0 sc1
  buffer_load_dwordx4 v[36:39], v20, s[32:35], s59 offen offset:2048 sc1
  s_sub_u32 s54, s54, 1
  s_cbranch_scc1 L_end
  s_waitcnt vmcnt(0)
  v_cmp_ne_u32 vcc, s48, v35
  v_cmp_ne_u32 s[52:53], s48, v39
  s_nop 0
  s_or_b64 vcc, vcc, s[52:53]
  s_mov_b64 exec, vcc
  s_cbranch_vccnz L_poll_5
  s_mov_b64 exec, -1
L_ffn_gota:
  v_perm_b32 v35, v33, v32, s64
  v_perm_b32 v35, v34, v35, s65
  v_perm_b32 v39, v37, v36, s64
  v_perm_b32 v39, v38, v39, s65
  v_pk_add_f32 v[32:33], v[32:33], v[36:37]
  v_pk_add_f32 v[34:35], v[34:35], v[38:39]
  s_nop 1
  v_permlane32_swap_b32 v32, v34
  v_permlane32_swap_b32 v33, v35
  v_pk_add_f32 v[32:33], v[32:33], v[34:35]
  s_nop 1
  v_permlane16_swap_b32 v32, v33
  v_add_f32 v26, v32, v33
  v_fma_f32 v25, v26, v162, v160
  v_add_f32 v26, v26, v19
  s_nop 0
  v_mov_b32_dpp v27, v25 quad_perm:[1,1,3,3] row_mask:0xf bank_mask:0xf
  v_cvt_pk_bf16_f32 v28, v25, v27
  s_nop 1
  v_mov_b32_dpp v29, v28 row_shl:2 row_mask:0xf bank_mask:0xf
  v_mov_b32_dpp v30, v28 row_shl:4 row_mask:0xf bank_mask:0xf
  v_mov_b32_dpp v31, v28 row_shl:6 row_mask:0xf bank_mask:0xf
  s_nop 1
  v_mfma_f32_16x16x32_bf16 v[96:99], v[28:31], v[64:67], 0
  v_mul_f32 v27, v26, v26
  v_mfma_f32_16x16x32_bf16 v[100:103], v[28:31], v[68:71], 0
  s_nop 0
  v_mfma_f32_16x16x32_bf16 v[104:107], v[28:31], v[72:75], 0
  v_permlane32_swap_b32 v26, v27
  v_mfma_f32_16x16x32_bf16 v[108:111], v[28:31], v[76:79], 0
  v_add_f32 v26, v26, v27
  v_mfma_f32_16x16x32_bf16 v[112:115], v[28:31], v[80:83], 0
  s_nop 0
  v_add_f32_dpp v26, v26, v26 quad_perm:[1,0,3,2] row_mask:0xf bank_mask:0xf
  v_mfma_f32_16x16x32_bf16 v[116:119], v[28:31], v[84:87], 0
  s_nop 0
  v_add_f32_dpp v26, v26, v26 quad_perm:[2,3,0,1] row_mask:0xf bank_mask:0xf
  v_mfma_f32_16x16x32_bf16 v[120:123], v[28:31], v[88:91], 0
  s_nop 0
  v_add_f32_dpp v26, v26, v26 row_half_mirror row_mask:0xf bank_mask:0xf
  v_mfma_f32_16x16x32_bf16 v[124:127], v[28:31], v[92:95], 0
  s_nop 0
  v_add_f32_dpp v26, v26, v26 row_mirror row_mask:0xf bank_mask:0xf
  s_nop 1
  v_add_f32_dpp v26, v26, v26 row_bcast:15 row_mask:0xa bank_mask:0xf
  s_mov_b32 exec_lo, 0x00010000
  s_mov_b32 exec_hi, 0x00010000
  ds_write_b32 v23, v26 offset:16128
  s_mov_b32 exec_lo, 0xff
  s_mov_b32 exec_hi, 0xff00
  ds_write2_b32 v22, v96, v100 offset0:0 offset1:20
  ds_write2_b32 v22, v104, v108 offset0:40 offset1:60
  ds_write2_b32 v22, v112, v116 offset0:80 offset1:100
  ds_write2_b32 v22, v120, v124 offset0:120 offset1:140
  s_mov_b64 exec, -1
  s_waitcnt lgkmcnt(0)
  s_barrier
  s_cmp_eq_u32 s68, 0
  s_cbranch_scc1 L_end
  ds_read_b128 v[48:51], v24 offset:16128
  ds_read_b128 v[52:55], v24 offset:16144
  ds_read_b128 v[56:59], v24 offset:16160
  ds_read_b128 v[60:63], v24 offset:16176
  ds_read_b128 v[32:35], v14 offset:10752
  ds_read_b128 v[36:39], v14 offset:10768
  ds_read_b128 v[40:43], v14 offset:10784
  ds_read_b128 v[44:47], v14 offset:10800
  s_waitcnt lgkmcnt(4)
  v_pk_add_f32 v[48:49], v[48:49], v[50:51]
  v_pk_add_f32 v[52:53], v[52:53], v[54:55]
  v_pk_add_f32 v[56:57], v[56:57], v[58:59]
  v_pk_add_f32 v[60:61], v[60:61], v[62:63]
  v_pk_add_f32 v[48:49], v[48:49], v[52:53]
  v_pk_add_f32 v[56:57], v[56:57], v[60:61]
  v_pk_add_f32 v[48:49], v[48:49], v[56:57]
  v_mul_f32 v26, s67, v48
  v_fma_f32 v27, v49, s67, v7
  v_fma_f32 v27, -v26, v26, v27
  v_max_f32 v27, v27, v7
  v_rsq_f32 v27, v27
  s_waitcnt lgkmcnt(0)
  v_pk_add_f32 v[32:33], v[32:33], v[40:41]
  v_pk_add_f32 v[34:35], v[34:35], v[42:43]
  v_pk_add_f32 v[36:37], v[36:37], v[44:45]
  v_pk_add_f32 v[38:39], v[38:39], v[46:47]
  v_pk_add_f32 v[32:33], v[32:33], v[36:37]
  v_pk_add_f32 v[34:35], v[34:35], v[38:39]
  v_pk_add_f32 v[32:33], v[32:33], v[34:35]
  v_fma_f32 v20, -v26, v163, v32
  v_add_f32 v20, v20, v33
  v_fma_f32 v20, v20, v27, v161
  v_mul_f32 v22, v20, v20
  v_fma_f32 v22, v22, v11, v10
  v_mul_f32 v22, v22, v20
  v_exp_f32 v22, v22
  v_mul_f32_dpp v20, v20, v20 row_ror:8 row_mask:0xf bank_mask:0xf
  v_add_f32 v22, 1.0, v22
  v_rcp_f32 v22, v22
  v_cmp_eq_u32 vcc, 0, v16
  v_mul_f32 v20, v20, v22
  s_nop 1
  v_mov_b32_dpp v21, v20 quad_perm:[1,1,3,3] row_mask:0xf bank_mask:0xf
  v_cvt_pk_bf16_f32 v21, v20, v21
  s_nop 1
  v_mov_b32_dpp v28, v21 row_newbcast:0 row_mask:0xf bank_mask:0xf
  v_mov_b32_dpp v29, v21 row_newbcast:2 row_mask:0xf bank_mask:0xf
  v_mov_b32_dpp v30, v21 row_newbcast:4 row_mask:0xf bank_mask:0xf
  v_mov_b32_dpp v31, v21 row_newbcast:6 row_mask:0xf bank_mask:0xf
  s_nop 1
  v_mfma_f32_16x16x32_bf16 v[96:99], v[28:31], v[128:131], 0
  v_mfma_f32_16x16x32_bf16 v[112:115], v[28:31], v[144:147], 0
  v_mfma_f32_16x16x32_bf16 v[100:103], v[28:31], v[132:135], 0
  v_mfma_f32_16x16x32_bf16 v[116:119], v[28:31], v[148:151], 0
  v_mfma_f32_16x16x32_bf16 v[104:107], v[28:31], v[136:139], 0
  v_mfma_f32_16x16x32_bf16 v[120:123], v[28:31], v[152:155], 0
  v_mfma_f32_16x16x32_bf16 v[108:111], v[28:31], v[140:143], 0
  v_mfma_f32_16x16x32_bf16 v[124:127], v[28:31], v[156:159], 0
  s_nop 1
  v_cndmask_b32 v20, v112, v96, vcc
  s_nop 0
  v_cndmask_b32 v21, v116, v100, vcc
  s_nop 0
  v_cndmask_b32 v22, v120, v104, vcc
  s_nop 0
  v_cndmask_b32 v23, v124, v108, vcc
  v_perm_b32 v164, v20, v23, s61
  v_perm_b32 v165, v21, v23, s62
  v_perm_b32 v166, v22, v23, s63
  buffer_store_dwordx4 v[164:167], v15, s[32:35], s66 offen sc1
  s_branch L_end
L_D:
  s_mov_b32 s44, s12
  s_mov_b32 s45, s13
  s_mov_b32 s46, 4194304
  s_mov_b32 s47, 0x20000
  s_and_b32 s57, s2, 7
  s_lshr_b32 s58, s2, 3
  s_xor_b32 s58, s58, 4
  v_lshlrev_b32 v10, 2, v5
  v_lshl_add_u32 v10, v3, 4, v10
  v_lshlrev_b32 v10, 10, v10
  v_lshl_add_u32 v10, v6, 4, v10
  s_lshl_b32 s52, s57, 19
  s_lshl_b32 s53, s49, 16
  s_add_u32 s52, s52, s53
  s_lshl_b32 s53, s58, 7
  s_add_u32 s52, s52, s53
  v_add_u32 v10, s52, v10
  buffer_load_dwordx4 v[128:131], v10, s[44:47], 0 offen offset:0 nt
  s_mov_b32 s52, 8192
  buffer_load_dwordx4 v[132:135], v10, s[44:47], s52 offen nt
  buffer_load_dwordx4 v[136:139], v10, s[44:47], 0 offen offset:1024 nt
  s_mov_b32 s52, 9216
  buffer_load_dwordx4 v[140:143], v10, s[44:47], s52 offen nt
  s_cmp_lg_u32 s58, 3
  s_cbranch_scc1 L_D_now
  s_waitcnt vmcnt(1)
L_D_now:
  buffer_load_dwordx4 v[144:147], v10, s[44:47], 0 offen offset:2048 nt
  s_mov_b32 s52, 10240
  buffer_load_dwordx4 v[148:151], v10, s[44:47], s52 offen nt
  buffer_load_dwordx4 v[152:155], v10, s[44:47], 0 offen offset:3072 nt
  s_mov_b32 s52, 11264
  buffer_load_dwordx4 v[156:159], v10, s[44:47], s52 offen nt
  v_lshrrev_b32 v12, 3, v1
  v_lshlrev_b32 v14, 10, v12
  v_lshl_add_u32 v14, v6, 4, v14
  v_lshlrev_b32 v15, 5, v12
  s_lshl_b32 s66, s57, 17
  s_lshr_b32 s68, s49, 1
  s_lshl_b32 s52, s68, 13
  s_and_b32 s53, s49, 1
  s_lshl_b32 s53, s53, 8
  s_add_u32 s59, s52, s53
  s_add_u32 s59, s59, s66
  s_add_u32 s59, s59, 2195456
  s_lshl_b32 s52, s68, 8
  s_add_u32 s66, s66, s52
  s_add_u32 s66, s66, 2170880
  v_mul_u32_u24 v16, 672, v6
  v_lshl_add_u32 v16, v5, 2, v16
  s_lshl_b32 s52, s49, 3
  v_add_u32 v16, s52, v16
  v_lshlrev_b32 v9, 4, v2
  v_lshl_add_u32 v9, v3, 13, v9
  s_and_b32 s52, s57, 3
  s_lshl_b32 s52, s52, 11
  s_lshl_b32 s53, s58, 8
  s_add_u32 s67, s52, s53
  s_lshr_b32 s52, s57, 2
  s_lshl_b32 s52, s52, 14
  s_add_u32 s67, s67, s52
  s_add_u32 s67, s67, 65536
  v_mov_b32 v31, s48
  v_lshl_add_u32 v17, v2, 2, v3
  v_mul_u32_u24 v17, 80, v17
  v_lshrrev_b32 v4, 1, v2
  v_mad_u32_u24 v17, v4, 32, v17
  s_lshl_b32 s56, s58, 8
  s_add_u32 s56, s56, 2129920
  v_lshlrev_b32 v13, 4, v2
  v_lshl_add_u32 v13, v3, 18, v13
  s_cmp_lg_u32 s49, 0
  s_cbranch_scc1 L_D_nog1
  buffer_load_dwordx4 v[88:91], v13, s[32:35], s56 offen sc1
L_D_nog1:
  s_cmp_ge_u32 s49, 4
  s_cbranch_scc1 L_D_nop
  s_cmp_ge_u32 s2, 32
  s_cbranch_scc1 L_D_nop
  s_lshl_b32 s52, s2, 1
  s_bfe_u32 s53, s49, 0x10001
  s_add_u32 s52, s52, s53
  s_and_b32 s53, s52, 63
  s_lshl_b32 s53, s53, 7
  s_lshr_b32 s52, s52, 6
  s_lshl_b32 s52, s52, 14
  s_add_u32 s52, s52, s53
  s_add_u32 s52, s52, 1310720
  s_add_u32 s100, s30, s52
  s_addc_u32 s101, s31, 0
  s_mov_b32 s28, 0x7fffffff
  s_mov_b32 s29, 0x7fffffff
  s_memtime s[44:45]
  s_waitcnt lgkmcnt(0)
  s_load_dword s52, s[100:101], 0 glc
  s_waitcnt lgkmcnt(0)
  s_memtime s[46:47]
  s_waitcnt lgkmcnt(0)
  s_sub_u32 s53, s46, s44
  s_min_u32 s28, s28, s53
  s_memtime s[44:45]
  s_waitcnt lgkmcnt(0)
  s_load_dword s52, s[100:101], 8192 glc
  s_waitcnt lgkmcnt(0)
  s_memtime s[46:47]
  s_waitcnt lgkmcnt(0)
  s_sub_u32 s53, s46, s44
  s_min_u32 s29, s29, s53
  s_memtime s[44:45]
  s_waitcnt lgkmcnt(0)
  s_load_dword s52, s[100:101], 0 glc
  s_waitcnt lgkmcnt(0)
  s_memtime s[46:47]
  s_waitcnt lgkmcnt(0)
  s_sub_u32 s53, s46, s44
  s_min_u32 s28, s28, s53
  s_memtime s[44:45]
  s_waitcnt lgkmcnt(0)
  s_load_dword s52, s[100:101], 8192 glc
  s_waitcnt lgkmcnt(0)
  s_memtime s[46:47]
  s_waitcnt lgkmcnt(0)
  s_sub_u32 s53, s46, s44
  s_min_u32 s29, s29, s53
  s_cmp_gt_u32 s28, s29
  s_lshl_b32 s52, s49, 3
  v_mov_b32 v25, s52
  v_mov_b32 v26, s28
  v_mov_b32 v27, s29
  ds_write_b64 v25, v[26:27] offset:16384
L_D_nop:
  s_waitcnt vmcnt(0)
  s_add_u32 s52, s66, 1048576
  s_add_u32 s53, s59, 1048576
  buffer_load_dwordx4 v[80:83], v15, s[32:35], s52 offen sc1
  buffer_load_dwordx4 v[84:87], v15, s[32:35], s52 offen offset:16 sc1
  buffer_load_dwordx4 v[64:67], v14, s[32:35], s53 offen sc1
  buffer_load_dwordx4 v[68:71], v14, s[32:35], s53 offen offset:128 sc1
  buffer_load_dwordx4 v[72:75], v14, s[32:35], s53 offen offset:512 sc1
  buffer_load_dwordx4 v[76:79], v14, s[32:35], s53 offen offset:640 sc1
  v_perm_b32 v32, v132, v128, s50
  v_perm_b32 v36, v132, v128, s51
  v_perm_b32 v40, v133, v129, s50
  v_perm_b32 v44, v133, v129, s51
  v_perm_b32 v48, v134, v130, s50
  v_perm_b32 v52, v134, v130, s51
  v_perm_b32 v56, v135, v131, s50
  v_perm_b32 v60, v135, v131, s51
  v_perm_b32 v33, v140, v136, s50
  v_perm_b32 v37, v140, v136, s51
  v_perm_b32 v41, v141, v137, s50
  v_perm_b32 v45, v141, v137, s51
  v_perm_b32 v49, v142, v138, s50
  v_perm_b32 v53, v142, v138, s51
  v_perm_b32 v57, v143, v139, s50
  v_perm_b32 v61, v143, v139, s51
  v_perm_b32 v34, v148, v144, s50
  v_perm_b32 v38, v148, v144, s51
  v_perm_b32 v42, v149, v145, s50
  v_perm_b32 v46, v149, v145, s51
  v_perm_b32 v50, v150, v146, s50
  v_perm_b32 v54, v150, v146, s51
  v_perm_b32 v58, v151, v147, s50
  v_perm_b32 v62, v151, v147, s51
  v_perm_b32 v35, v156, v152, s50
  v_perm_b32 v39, v156, v152, s51
  v_perm_b32 v43, v157, v153, s50
  v_perm_b32 v47, v157, v153, s51
  v_perm_b32 v51, v158, v154, s50
  v_perm_b32 v55, v158, v154, s51
  v_perm_b32 v59, v159, v155, s50
  v_perm_b32 v63, v159, v155, s51
  s_cmp_lg_u32 s49, 0
  s_cbranch_scc1 L_D_noga
  s_waitcnt vmcnt(0)
  v_cmp_ne_u32 vcc, s48, v91
  s_nop 0
  s_cbranch_vccz L_D_gotga
  s_mov_b64 exec, vcc
L_poll_6:
  s_sleep 1
  buffer_load_dwordx4 v[88:91], v13, s[32:35], s56 offen offset:0 sc1
  s_sub_u32 s54, s54, 1
  s_cbranch_scc1 L_end
  s_waitcnt vmcnt(0)
  v_cmp_ne_u32 vcc, s48, v91
  s_nop 0
  s_mov_b64 exec, vcc
  s_cbranch_vccnz L_poll_6
  s_mov_b64 exec, -1
L_D_gotga:
  v_perm_b32 v91, v89, v88, s64
  v_perm_b32 v91, v90, v91, s65
  v_permlane32_swap_b32 v88, v90
  s_nop 0
  v_permlane32_swap_b32 v89, v91
  v_add_f32 v88, v88, v90
  v_add_f32 v89, v89, v91
  s_nop 1
  v_permlane16_swap_b32 v88, v89
  v_add_f32 v24, v88, v89
  v_cvt_pk_bf16_f32 v24, v24, v24
  v_and_b32 v24, s60, v24
L_D_noga:
  s_waitcnt vmcnt(0)
  v_cmp_ne_u32 vcc, s48, v83
  v_cmp_ne_u32 s[52:53], s48, v87
  s_nop 0
  s_or_b64 vcc, vcc, s[52:53]
  s_cbranch_vccz L_D_gotml
  s_mov_b64 exec, vcc
  s_or_b32 s54, s54, 31
L_poll_7:
  s_sleep 1
  s_and_b32 s69, s54, 31
  s_cselect_b32 s69, 1048576, 0
  s_add_u32 s69, s69, s66
  buffer_load_dwordx4 v[80:83], v15, s[32:35], s69 offen offset:0 sc1
  buffer_load_dwordx4 v[84:87], v15, s[32:35], s69 offen offset:16 sc1
  s_sub_u32 s54, s54, 1
  s_cbranch_scc1 L_end
  s_waitcnt vmcnt(0)
  v_cmp_ne_u32 vcc, s48, v83
  v_cmp_ne_u32 s[52:53], s48, v87
  s_nop 0
  s_or_b64 vcc, vcc, s[52:53]
  s_mov_b64 exec, vcc
  s_cbranch_vccnz L_poll_7
  s_mov_b64 exec, -1
L_D_gotml:
  v_max_f32 v18, v80, v84
  s_nop 1
  v_max_f32_dpp v18, v18, v18 row_ror:8 row_mask:0xf bank_mask:0xf
  v_mov_b32 v19, v18
  s_nop 1
  v_permlane16_swap_b32 v18, v19
  v_max_f32 v18, v18, v19
  v_mov_b32 v19, v18
  s_nop 1
  v_permlane32_swap_b32 v18, v19
  v_max_f32 v18, v18, v19
  v_sub_f32 v80, v80, v18
  v_sub_f32 v84, v84, v18
  v_mul_f32 v80, 0x3fb8aa3b, v80
  v_mul_f32 v84, 0x3fb8aa3b, v84
  v_exp_f32 v80, v80
  v_exp_f32 v84, v84
  v_mul_f32 v19, v80, v81
  v_fmac_f32 v19, v84, v85
  s_nop 1
  v_add_f32_dpp v19, v19, v19 row_ror:8 row_mask:0xf bank_mask:0xf
  v_mov_b32 v18, v19
  s_nop 1
  v_permlane16_swap_b32 v19, v18
  v_add_f32 v19, v19, v18
  v_mov_b32 v18, v19
  s_nop 1
  v_permlane32_swap_b32 v19, v18
  v_add_f32 v19, v19, v18
  v_rcp_f32 v19, v19
  s_nop 0
  v_mul_f32 v20, v80, v19
  v_mul_f32 v22, v84, v19
  v_mov_b32 v21, v20
  v_mov_b32 v23, v22
  s_waitcnt vmcnt(0)
  v_cmp_ne_u32 vcc, s48, v67
  v_cmp_ne_u32 s[52:53], s48, v71
  s_nop 0
  s_or_b64 vcc, vcc, s[52:53]
  v_cmp_ne_u32 s[52:53], s48, v75
  s_nop 0
  s_or_b64 vcc, vcc, s[52:53]
  v_cmp_ne_u32 s[52:53], s48, v79
  s_nop 0
  s_or_b64 vcc, vcc, s[52:53]
  s_cbranch_vccz L_D_gotop
  s_mov_b64 exec, vcc
  s_or_b32 s54, s54, 31
L_poll_8:
  s_and_b32 s69, s54, 31
  s_cselect_b32 s69, 1048576, 0
  s_add_u32 s69, s69, s59
  buffer_load_dwordx4 v[64:67], v14, s[32:35], s69 offen offset:0 sc1
  buffer_load_dwordx4 v[68:71], v14, s[32:35], s69 offen offset:128 sc1
  buffer_load_dwordx4 v[72:75], v14, s[32:35], s69 offen offset:512 sc1
  buffer_load_dwordx4 v[76:79], v14, s[32:35], s69 offen offset:640 sc1
  s_sub_u32 s54, s54, 1
  s_cbranch_scc1 L_end
  s_waitcnt vmcnt(0)
  v_cmp_ne_u32 vcc, s48, v67
  v_cmp_ne_u32 s[52:53], s48, v71
  s_nop 0
  s_or_b64 vcc, vcc, s[52:53]
  v_cmp_ne_u32 s[52:53], s48, v75
  s_nop 0
  s_or_b64 vcc, vcc, s[52:53]
  v_cmp_ne_u32 s[52:53], s48, v79
  s_nop 0
  s_or_b64 vcc, vcc, s[52:53]
  s_mov_b64 exec, vcc
  s_cbranch_vccnz L_poll_8
  s_mov_b64 exec, -1
L_D_gotop:
  v_perm_b32 v67, v65, v64, s64
  v_perm_b32 v67, v66, v67, s65
  v_perm_b32 v71, v69, v68, s64
  v_perm_b32 v71, v70, v71, s65
  v_perm_b32 v75, v73, v72, s64
  v_perm_b32 v75, v74, v75, s65
  v_perm_b32 v79, v77, v76, s64
  v_perm_b32 v79, v78, v79, s65
  v_pk_mul_f32 v[64:65], v[64:65], v[20:21]
  v_pk_mul_f32 v[66:67], v[66:67], v[20:21]
  v_pk_mul_f32 v[68:69], v[68:69], v[20:21]
  v_pk_mul_f32 v[70:71], v[70:71], v[20:21]
  v_pk_fma_f32 v[64:65], v[72:73], v[22:23], v[64:65]
  v_pk_fma_f32 v[66:67], v[74:75], v[22:23], v[66:67]
  v_pk_fma_f32 v[68:69], v[76:77], v[22:23], v[68:69]
  v_pk_fma_f32 v[70:71], v[78:79], v[22:23], v[70:71]
  s_nop 0
  v_permlane32_swap_b32 v64, v68
  v_permlane32_swap_b32 v65, v69
  v_permlane32_swap_b32 v66, v70
  v_permlane32_swap_b32 v67, v71
  v_pk_add_f32 v[64:65], v[64:65], v[68:69]
  v_pk_add_f32 v[66:67], v[66:67], v[70:71]
  s_nop 1
  v_permlane16_swap_b32 v64, v66
  v_permlane16_swap_b32 v65, v67
  v_pk_add_f32 v[64:65], v[64:65], v[66:67]
  s_nop 1
  v_add_f32_dpp v64, v64, v64 row_ror:8 row_mask:0xf bank_mask:0xf
  v_add_f32_dpp v65, v65, v65 row_ror:8 row_mask:0xf bank_mask:0xf
  v_cvt_pk_bf16_f32 v64, v64, v65
  s_nop 1
  v_mov_b32_dpp v72, v64 quad_perm:[0,0,0,0] row_mask:0xf bank_mask:0xf
  v_mov_b32_dpp v73, v64 quad_perm:[1,1,1,1] row_mask:0xf bank_mask:0xf
  v_mov_b32_dpp v74, v64 quad_perm:[2,2,2,2] row_mask:0xf bank_mask:0xf
  v_mov_b32_dpp v75, v64 quad_perm:[3,3,3,3] row_mask:0xf bank_mask:0xf
  s_nop 1
  v_mfma_f32_16x16x32_bf16 v[96:99], v[72:75], v[32:35], 0
  v_mfma_f32_16x16x32_bf16 v[100:103], v[72:75], v[36:39], 0
  v_mfma_f32_16x16x32_bf16 v[104:107], v[72:75], v[40:43], 0
  v_mfma_f32_16x16x32_bf16 v[108:111], v[72:75], v[44:47], 0
  v_mfma_f32_16x16x32_bf16 v[112:115], v[72:75], v[48:51], 0
  v_mfma_f32_16x16x32_bf16 v[116:119], v[72:75], v[52:55], 0
  v_mfma_f32_16x16x32_bf16 v[120:123], v[72:75], v[56:59], 0
  v_mfma_f32_16x16x32_bf16 v[124:127], v[72:75], v[60:63], 0
  s_mov_b32 exec_lo, 0xff0000ff
  s_mov_b32 exec_hi, 0x0
  ds_write2_b32 v16, v96, v100 offset0:0 offset1:20
  s_nop 0
  ds_write2_b32 v16, v104, v108 offset0:40 offset1:60
  s_nop 0
  ds_write2_b32 v16, v112, v116 offset0:80 offset1:100
  s_nop 0
  ds_write2_b32 v16, v120, v124 offset0:120 offset1:140
  s_mov_b64 exec, -1
  s_waitcnt lgkmcnt(0)
  s_barrier
  s_cmp_lg_u32 s49, 0
  s_cbranch_scc1 L_end
  ds_read_b128 v[64:67], v17 offset:0
  ds_read_b128 v[68:71], v17 offset:16
  ds_read_b128 v[72:75], v17 offset:32
  ds_read_b128 v[76:79], v17 offset:48
  s_waitcnt lgkmcnt(0)
  v_pk_add_f32 v[64:65], v[64:65], v[72:73]
  v_pk_add_f32 v[66:67], v[66:67], v[74:75]
  v_pk_add_f32 v[68:69], v[68:69], v[76:77]
  v_pk_add_f32 v[70:71], v[70:71], v[78:79]
  v_pk_add_f32 v[64:65], v[64:65], v[68:69]
  v_pk_add_f32 v[66:67], v[66:67], v[70:71]
  v_pk_add_f32 v[64:65], v[64:65], v[66:67]
  v_add_f32 v20, v64, v65
  v_mul_f32 v20, v20, v24
  v_mov_b32 v21, v20
  s_nop 1
  v_permlane16_swap_b32 v20, v21
  v_mov_b32 v22, v20
  v_mov_b32 v23, v21
  s_nop 0
  v_permlane32_swap_b32 v20, v22
  v_permlane32_swap_b32 v21, v23
  v_perm_b32 v28, v20, v23, s61
  v_perm_b32 v29, v21, v23, s62
  v_perm_b32 v30, v22, v23, s63
  s_mov_b32 exec_hi, 0
  buffer_store_dwordx4 v[28:31], v9, s[32:35], s67 offen sc1
  s_mov_b64 exec, -1
  s_cmp_ge_u32 s2, 32
  s_cbranch_scc1 L_end
  s_mov_b32 s36, s4
  s_mov_b32 s37, s5
  s_mov_b32 s38, 1024
  s_mov_b32 s39, 0x20000
  s_mov_b32 s40, s26
  s_mov_b32 s41, s27
  s_mov_b32 s42, 1024
  s_mov_b32 s43, 0x20000
  v_and_b32 v5, 3, v1
  v_lshrrev_b32 v6, 2, v1
  s_lshl_b32 s52, s2, 2
  v_add_u32 v5, s52, v5
  v_lshlrev_b32 v8, 4, v5
  v_and_b32 v13, 3, v6
  v_lshlrev_b32 v11, 11, v13
  v_bfe_u32 v12, v6, 2, 1
  v_lshl_add_u32 v12, v12, 14, v11
  v_lshl_add_u32 v11, v3, 14, v11
  v_add_u32 v9, v11, v8
  v_add_u32 v14, v12, v8
  v_and_b32 v7, 15, v5
  v_lshlrev_b32 v7, 1, v7
  v_and_b32 v8, 0x60, v5
  v_bfe_u32 v5, v5, 4, 1
  v_add3_u32 v5, v5, v7, v8
  v_lshl_add_u32 v7, v5, 2, v3
  v_lshlrev_b32 v7, 1, v7
  buffer_load_ushort v10, v7, s[36:39], 0 offen
  v_lshlrev_b32 v8, 4, v5
  v_add_u32 v12, v12, v8
  v_lshl_add_u32 v13, v13, 18, v8
  s_mov_b32 s59, 2129920
  s_mov_b32 s57, 2136064
  s_nop 0
  v_mov_b32 v25, 0
  ds_read_b128 v[40:43], v25 offset:16384
  ds_read_b128 v[44:47], v25 offset:16400
  s_waitcnt lgkmcnt(0)
  v_min3_u32 v40, v40, v42, v44
  v_min3_u32 v41, v41, v43, v45
  v_min_u32 v40, v40, v46
  v_min_u32 v40, 490, v40
  v_min_u32 v41, v41, v47
  v_cmp_gt_u32 vcc, v40, v41
  s_nop 0
  s_cmp_lg_u64 vcc, 0
  s_cselect_b32 s99, 0x2000, 0
  s_add_u32 s58, s99, 65536
L_poll_9:
  buffer_load_dwordx4 v[20:23], v13, s[32:35], s57 offen offset:0 sc1
  buffer_load_dwordx4 v[24:27], v12, s[32:35], s58 offen offset:0 sc1
  s_sub_u32 s54, s54, 1
  s_cbranch_scc1 L_end
  s_waitcnt vmcnt(0)
  v_cmp_ne_u32 vcc, s48, v23
  v_cmp_ne_u32 s[52:53], s48, v27
  s_nop 0
  s_or_b64 vcc, vcc, s[52:53]
  s_mov_b64 exec, vcc
  s_cbranch_vccnz L_poll_9
  s_mov_b64 exec, -1
  v_perm_b32 v23, v21, v20, s64
  v_perm_b32 v23, v22, v23, s65
  v_permlane32_swap_b32 v20, v22
  s_nop 0
  v_permlane32_swap_b32 v21, v23
  v_add_f32 v20, v20, v22
  v_add_f32 v21, v21, v23
  s_nop 1
  v_permlane16_swap_b32 v20, v21
  v_add_f32 v20, v20, v21
  v_perm_b32 v27, v25, v24, s64
  v_perm_b32 v27, v26, v27, s65
  v_permlane32_swap_b32 v24, v26
  s_nop 0
  v_permlane32_swap_b32 v25, v27
  v_add_f32 v24, v24, v26
  v_add_f32 v25, v25, v27
  s_nop 1
  v_permlane16_swap_b32 v24, v25
  v_add_f32 v24, v24, v25
  v_add_f32_dpp v20, v20, v20 row_ror:4 row_mask:0xf bank_mask:0xf
  s_nop 0
  v_add_f32_dpp v24, v24, v24 row_ror:4 row_mask:0xf bank_mask:0xf
  v_add_f32_dpp v20, v20, v20 row_ror:8 row_mask:0xf bank_mask:0xf
  s_nop 0
  v_add_f32_dpp v24, v24, v24 row_ror:8 row_mask:0xf bank_mask:0xf
  v_mul_f32 v20, 0x3e800000, v20
  v_cvt_pk_bf16_f32 v20, v20, v20
  v_and_b32 v20, s60, v20
  v_lshlrev_b32 v10, 16, v10
  v_fma_f32 v24, v24, 0.5, v10
  s_add_u32 s59, s99, 1048576
  s_add_u32 s57, s99, 1114112
  s_add_u32 s58, s99, 1179648
  s_add_u32 s66, s99, 1245184
  v_mov_b32 v28, 0.5
  v_mov_b32 v29, 0.5
L_poll_10:
  buffer_load_dwordx4 v[48:51], v9, s[32:35], s59 offen offset:0 sc1
  buffer_load_dwordx4 v[52:55], v9, s[32:35], s57 offen offset:0 sc1
  buffer_load_dwordx4 v[56:59], v9, s[32:35], s58 offen offset:0 sc1
  buffer_load_dwordx4 v[60:63], v14, s[32:35], s66 offen offset:0 sc1
  s_sub_u32 s54, s54, 1
  s_cbranch_scc1 L_end
  s_waitcnt vmcnt(0)
  v_cmp_ne_u32 vcc, s48, v51
  v_cmp_ne_u32 s[52:53], s48, v55
  s_nop 0
  s_or_b64 vcc, vcc, s[52:53]
  v_cmp_ne_u32 s[52:53], s48, v59
  s_nop 0
  s_or_b64 vcc, vcc, s[52:53]
  v_cmp_ne_u32 s[52:53], s48, v63
  s_nop 0
  s_or_b64 vcc, vcc, s[52:53]
  s_mov_b64 exec, vcc
  s_cbranch_vccnz L_poll_10
  s_mov_b64 exec, -1
  v_perm_b32 v51, v49, v48, s64
  v_perm_b32 v51, v50, v51, s65
  v_perm_b32 v55, v53, v52, s64
  v_perm_b32 v55, v54, v55, s65
  v_perm_b32 v59, v57, v56, s64
  v_perm_b32 v59, v58, v59, s65
  v_perm_b32 v63, v61, v60, s64
  v_perm_b32 v63, v62, v63, s65
  v_pk_add_f32 v[48:49], v[48:49], v[52:53]
  v_pk_add_f32 v[50:51], v[50:51], v[54:55]
  v_pk_fma_f32 v[56:57], v[60:61], v[28:29], v[56:57]
  v_pk_fma_f32 v[58:59], v[62:63], v[28:29], v[58:59]
  v_pk_add_f32 v[48:49], v[48:49], v[56:57]
  v_pk_add_f32 v[50:51], v[50:51], v[58:59]
  s_nop 1
  v_permlane32_swap_b32 v48, v50
  v_permlane32_swap_b32 v49, v51
  v_add_f32 v48, v48, v50
  v_add_f32 v49, v49, v51
  s_nop 1
  v_permlane16_swap_b32 v48, v49
  v_add_f32 v48, v48, v49
  s_nop 1
  v_add_f32_dpp v48, v48, v48 row_ror:4 row_mask:0xf bank_mask:0xf
  s_nop 1
  v_add_f32_dpp v48, v48, v48 row_ror:8 row_mask:0xf bank_mask:0xf
  v_fma_f32 v48, v48, v20, v24
  v_cvt_pk_bf16_f32 v48, v48, v48
  s_mov_b32 exec_lo, 0x000F000F
  s_mov_b32 exec_hi, 0x000F000F
  buffer_store_short v48, v7, s[40:43], 0 offen
  s_cmp_lg_u32 s2, 0
  s_cbranch_scc1 L_red_done
  s_mov_b64 exec, 1
  s_add_u32 s52, s55, 1
  v_mov_b32 v5, 0
  v_mov_b32 v6, s52
  buffer_store_dword v6, v5, s[32:35], 0 offen sc1
L_red_done:
  s_mov_b64 exec, -1
  s_branch L_end
L_K_body:
  s_barrier
  v_and_b32 v9, 31, v1
  v_lshrrev_b32 v10, 5, v1
  v_lshlrev_b32 v8, 4, v2
  v_and_b32 v11, 1, v3
  v_lshl_add_u32 v8, v11, 8, v8
  v_lshl_add_u32 v8, v10, 11, v8
  v_lshlrev_b32 v9, 3, v9
  v_lshl_add_u32 v9, v10, 2, v9
  s_mul_i32 s52, s49, 272
  v_add_u32 v9, s52, v9
  v_mul_u32_u24 v12, 272, v6
  v_lshl_add_u32 v12, v3, 6, v12
  v_lshrrev_b32 v13, 1, v5
  v_lshlrev_b32 v13, 8, v13
  v_lshl_add_u32 v13, v6, 6, v13
  v_lshl_add_u32 v13, v3, 4, v13
  v_and_b32 v14, 1, v5
  v_lshl_add_u32 v13, v14, 3, v13
  s_lshl_b32 s52, s49, 9
  v_add_u32 v13, s52, v13
  s_lshl_b32 s52, s49, 3
  v_lshl_add_u32 v14, v6, 5, s52
  v_and_b32 v15, 1, v1
  v_cmp_eq_u32 s[44:45], 1, v15
  v_and_b32 v15, 2, v1
  v_cmp_eq_u32 s[46:47], 2, v15
  v_mov_b32 v161, 1
  s_lshl_b32 s52, s49, 2
  v_mov_b32 v162, s52
  v_lshlrev_b32 v163, 2, v6
  s_lshl_b32 s59, s57, 17
  s_lshl_b32 s52, s49, 9
  s_add_u32 s59, s59, s52
  s_add_u32 s59, s59, 2162688
  s_waitcnt lgkmcnt(0)
  s_mul_i32 s48, s55, 0x9E3779B1
  s_add_u32 s48, s48, 0x7F4A7C15
  s_waitcnt vmcnt(12)
  s_mov_b64 vcc, s[44:45]
  v_cndmask_b32_dpp v100, v32, v36, vcc quad_perm:[1,0,3,2] row_mask:0xf bank_mask:0xf
  v_cndmask_b32_dpp v108, v40, v44, vcc quad_perm:[1,0,3,2] row_mask:0xf bank_mask:0xf
  v_cndmask_b32_dpp v101, v33, v37, vcc quad_perm:[1,0,3,2] row_mask:0xf bank_mask:0xf
  v_cndmask_b32_dpp v109, v41, v45, vcc quad_perm:[1,0,3,2] row_mask:0xf bank_mask:0xf
  v_cndmask_b32_dpp v102, v34, v38, vcc quad_perm:[1,0,3,2] row_mask:0xf bank_mask:0xf
  v_cndmask_b32_dpp v110, v42, v46, vcc quad_perm:[1,0,3,2] row_mask:0xf bank_mask:0xf
  v_cndmask_b32_dpp v103, v35, v39, vcc quad_perm:[1,0,3,2] row_mask:0xf bank_mask:0xf
  v_cndmask_b32_dpp v111, v43, v47, vcc quad_perm:[1,0,3,2] row_mask:0xf bank_mask:0xf
  s_not_b64 vcc, vcc
  v_cndmask_b32_dpp v96, v36, v32, vcc quad_perm:[1,0,3,2] row_mask:0xf bank_mask:0xf
  v_cndmask_b32_dpp v104, v44, v40, vcc quad_perm:[1,0,3,2] row_mask:0xf bank_mask:0xf
  v_cndmask_b32_dpp v97, v37, v33, vcc quad_perm:[1,0,3,2] row_mask:0xf bank_mask:0xf
  v_cndmask_b32_dpp v105, v45, v41, vcc quad_perm:[1,0,3,2] row_mask:0xf bank_mask:0xf
  v_cndmask_b32_dpp v98, v38, v34, vcc quad_perm:[1,0,3,2] row_mask:0xf bank_mask:0xf
  v_cndmask_b32_dpp v106, v46, v42, vcc quad_perm:[1,0,3,2] row_mask:0xf bank_mask:0xf
  v_cndmask_b32_dpp v99, v39, v35, vcc quad_perm:[1,0,3,2] row_mask:0xf bank_mask:0xf
  v_cndmask_b32_dpp v107, v47, v43, vcc quad_perm:[1,0,3,2] row_mask:0xf bank_mask:0xf
  s_mov_b64 vcc, s[46:47]
  v_cndmask_b32_dpp v40, v96, v104, vcc quad_perm:[2,3,0,1] row_mask:0xf bank_mask:0xf
  v_cndmask_b32_dpp v44, v100, v108, vcc quad_perm:[2,3,0,1] row_mask:0xf bank_mask:0xf
  v_cndmask_b32_dpp v41, v97, v105, vcc quad_perm:[2,3,0,1] row_mask:0xf bank_mask:0xf
  v_cndmask_b32_dpp v45, v101, v109, vcc quad_perm:[2,3,0,1] row_mask:0xf bank_mask:0xf
  v_cndmask_b32_dpp v42, v98, v106, vcc quad_perm:[2,3,0,1] row_mask:0xf bank_mask:0xf
  v_cndmask_b32_dpp v46, v102, v110, vcc quad_perm:[2,3,0,1] row_mask:0xf bank_mask:0xf
  v_cndmask_b32_dpp v43, v99, v107, vcc quad_perm:[2,3,0,1] row_mask:0xf bank_mask:0xf
  v_cndmask_b32_dpp v47, v103, v111, vcc quad_perm:[2,3,0,1] row_mask:0xf bank_mask:0xf
  s_not_b64 vcc, vcc
  v_cndmask_b32_dpp v32, v104, v96, vcc quad_perm:[2,3,0,1] row_mask:0xf bank_mask:0xf
  v_cndmask_b32_dpp v36, v108, v100, vcc quad_perm:[2,3,0,1] row_mask:0xf bank_mask:0xf
  v_cndmask_b32_dpp v33, v105, v97, vcc quad_perm:[2,3,0,1] row_mask:0xf bank_mask:0xf
  v_cndmask_b32_dpp v37, v109, v101, vcc quad_perm:[2,3,0,1] row_mask:0xf bank_mask:0xf
  v_cndmask_b32_dpp v34, v106, v98, vcc quad_perm:[2,3,0,1] row_mask:0xf bank_mask:0xf
  v_cndmask_b32_dpp v38, v110, v102, vcc quad_perm:[2,3,0,1] row_mask:0xf bank_mask:0xf
  v_cndmask_b32_dpp v35, v107, v99, vcc quad_perm:[2,3,0,1] row_mask:0xf bank_mask:0xf
  v_cndmask_b32_dpp v39, v111, v103, vcc quad_perm:[2,3,0,1] row_mask:0xf bank_mask:0xf
  s_waitcnt vmcnt(8)
  s_mov_b64 vcc, s[44:45]
  v_cndmask_b32_dpp v100, v48, v52, vcc quad_perm:[1,0,3,2] row_mask:0xf bank_mask:0xf
  v_cndmask_b32_dpp v108, v56, v60, vcc quad_perm:[1,0,3,2] row_mask:0xf bank_mask:0xf
  v_cndmask_b32_dpp v101, v49, v53, vcc quad_perm:[1,0,3,2] row_mask:0xf bank_mask:0xf
  v_cndmask_b32_dpp v109, v57, v61, vcc quad_perm:[1,0,3,2] row_mask:0xf bank_mask:0xf
  v_cndmask_b32_dpp v102, v50, v54, vcc quad_perm:[1,0,3,2] row_mask:0xf bank_mask:0xf
  v_cndmask_b32_dpp v110, v58, v62, vcc quad_perm:[1,0,3,2] row_mask:0xf bank_mask:0xf
  v_cndmask_b32_dpp v103, v51, v55, vcc quad_perm:[1,0,3,2] row_mask:0xf bank_mask:0xf
  v_cndmask_b32_dpp v111, v59, v63, vcc quad_perm:[1,0,3,2] row_mask:0xf bank_mask:0xf
  s_not_b64 vcc, vcc
  v_cndmask_b32_dpp v96, v52, v48, vcc quad_perm:[1,0,3,2] row_mask:0xf bank_mask:0xf
  v_cndmask_b32_dpp v104, v60, v56, vcc quad_perm:[1,0,3,2] row_mask:0xf bank_mask:0xf
  v_cndmask_b32_dpp v97, v53, v49, vcc quad_perm:[1,0,3,2] row_mask:0xf bank_mask:0xf
  v_cndmask_b32_dpp v105, v61, v57, vcc quad_perm:[1,0,3,2] row_mask:0xf bank_mask:0xf
  v_cndmask_b32_dpp v98, v54, v50, vcc quad_perm:[1,0,3,2] row_mask:0xf bank_mask:0xf
  v_cndmask_b32_dpp v106, v62, v58, vcc quad_perm:[1,0,3,2] row_mask:0xf bank_mask:0xf
  v_cndmask_b32_dpp v99, v55, v51, vcc quad_perm:[1,0,3,2] row_mask:0xf bank_mask:0xf
  v_cndmask_b32_dpp v107, v63, v59, vcc quad_perm:[1,0,3,2] row_mask:0xf bank_mask:0xf
  s_mov_b64 vcc, s[46:47]
  v_cndmask_b32_dpp v56, v96, v104, vcc quad_perm:[2,3,0,1] row_mask:0xf bank_mask:0xf
  v_cndmask_b32_dpp v60, v100, v108, vcc quad_perm:[2,3,0,1] row_mask:0xf bank_mask:0xf
  v_cndmask_b32_dpp v57, v97, v105, vcc quad_perm:[2,3,0,1] row_mask:0xf bank_mask:0xf
  v_cndmask_b32_dpp v61, v101, v109, vcc quad_perm:[2,3,0,1] row_mask:0xf bank_mask:0xf
  v_cndmask_b32_dpp v58, v98, v106, vcc quad_perm:[2,3,0,1] row_mask:0xf bank_mask:0xf
  v_cndmask_b32_dpp v62, v102, v110, vcc quad_perm:[2,3,0,1] row_mask:0xf bank_mask:0xf
  v_cndmask_b32_dpp v59, v99, v107, vcc quad_perm:[2,3,0,1] row_mask:0xf bank_mask:0xf
  v_cndmask_b32_dpp v63, v103, v111, vcc quad_perm:[2,3,0,1] row_mask:0xf bank_mask:0xf
  s_not_b64 vcc, vcc
  v_cndmask_b32_dpp v48, v104, v96, vcc quad_perm:[2,3,0,1] row_mask:0xf bank_mask:0xf
  v_cndmask_b32_dpp v52, v108, v100, vcc quad_perm:[2,3,0,1] row_mask:0xf bank_mask:0xf
  v_cndmask_b32_dpp v49, v105, v97, vcc quad_perm:[2,3,0,1] row_mask:0xf bank_mask:0xf
  v_cndmask_b32_dpp v53, v109, v101, vcc quad_perm:[2,3,0,1] row_mask:0xf bank_mask:0xf
  v_cndmask_b32_dpp v50, v106, v98, vcc quad_perm:[2,3,0,1] row_mask:0xf bank_mask:0xf
  v_cndmask_b32_dpp v54, v110, v102, vcc quad_perm:[2,3,0,1] row_mask:0xf bank_mask:0xf
  v_cndmask_b32_dpp v51, v107, v99, vcc quad_perm:[2,3,0,1] row_mask:0xf bank_mask:0xf
  v_cndmask_b32_dpp v55, v111, v103, vcc quad_perm:[2,3,0,1] row_mask:0xf bank_mask:0xf
  s_waitcnt vmcnt(4)
  s_mov_b64 vcc, s[44:45]
  v_cndmask_b32_dpp v100, v64, v68, vcc quad_perm:[1,0,3,2] row_mask:0xf bank_mask:0xf
  v_cndmask_b32_dpp v108, v72, v76, vcc quad_perm:[1,0,3,2] row_mask:0xf bank_mask:0xf
  v_cndmask_b32_dpp v101, v65, v69, vcc quad_perm:[1,0,3,2] row_mask:0xf bank_mask:0xf
  v_cndmask_b32_dpp v109, v73, v77, vcc quad_perm:[1,0,3,2] row_mask:0xf bank_mask:0xf
  v_cndmask_b32_dpp v102, v66, v70, vcc quad_perm:[1,0,3,2] row_mask:0xf bank_mask:0xf
  v_cndmask_b32_dpp v110, v74, v78, vcc quad_perm:[1,0,3,2] row_mask:0xf bank_mask:0xf
  v_cndmask_b32_dpp v103, v67, v71, vcc quad_perm:[1,0,3,2] row_mask:0xf bank_mask:0xf
  v_cndmask_b32_dpp v111, v75, v79, vcc quad_perm:[1,0,3,2] row_mask:0xf bank_mask:0xf
  s_not_b64 vcc, vcc
  v_cndmask_b32_dpp v96, v68, v64, vcc quad_perm:[1,0,3,2] row_mask:0xf bank_mask:0xf
  v_cndmask_b32_dpp v104, v76, v72, vcc quad_perm:[1,0,3,2] row_mask:0xf bank_mask:0xf
  v_cndmask_b32_dpp v97, v69, v65, vcc quad_perm:[1,0,3,2] row_mask:0xf bank_mask:0xf
  v_cndmask_b32_dpp v105, v77, v73, vcc quad_perm:[1,0,3,2] row_mask:0xf bank_mask:0xf
  v_cndmask_b32_dpp v98, v70, v66, vcc quad_perm:[1,0,3,2] row_mask:0xf bank_mask:0xf
  v_cndmask_b32_dpp v106, v78, v74, vcc quad_perm:[1,0,3,2] row_mask:0xf bank_mask:0xf
  v_cndmask_b32_dpp v99, v71, v67, vcc quad_perm:[1,0,3,2] row_mask:0xf bank_mask:0xf
  v_cndmask_b32_dpp v107, v79, v75, vcc quad_perm:[1,0,3,2] row_mask:0xf bank_mask:0xf
  s_mov_b64 vcc, s[46:47]
  v_cndmask_b32_dpp v72, v96, v104, vcc quad_perm:[2,3,0,1] row_mask:0xf bank_mask:0xf
  v_cndmask_b32_dpp v76, v100, v108, vcc quad_perm:[2,3,0,1] row_mask:0xf bank_mask:0xf
  v_cndmask_b32_dpp v73, v97, v105, vcc quad_perm:[2,3,0,1] row_mask:0xf bank_mask:0xf
  v_cndmask_b32_dpp v77, v101, v109, vcc quad_perm:[2,3,0,1] row_mask:0xf bank_mask:0xf
  v_cndmask_b32_dpp v74, v98, v106, vcc quad_perm:[2,3,0,1] row_mask:0xf bank_mask:0xf
  v_cndmask_b32_dpp v78, v102, v110, vcc quad_perm:[2,3,0,1] row_mask:0xf bank_mask:0xf
  v_cndmask_b32_dpp v75, v99, v107, vcc quad_perm:[2,3,0,1] row_mask:0xf bank_mask:0xf
  v_cndmask_b32_dpp v79, v103, v111, vcc quad_perm:[2,3,0,1] row_mask:0xf bank_mask:0xf
  s_not_b64 vcc, vcc
  v_cndmask_b32_dpp v64, v104, v96, vcc quad_perm:[2,3,0,1] row_mask:0xf bank_mask:0xf
  v_cndmask_b32_dpp v68, v108, v100, vcc quad_perm:[2,3,0,1] row_mask:0xf bank_mask:0xf
  v_cndmask_b32_dpp v65, v105, v97, vcc quad_perm:[2,3,0,1] row_mask:0xf bank_mask:0xf
  v_cndmask_b32_dpp v69, v109, v101, vcc quad_perm:[2,3,0,1] row_mask:0xf bank_mask:0xf
  v_cndmask_b32_dpp v66, v106, v98, vcc quad_perm:[2,3,0,1] row_mask:0xf bank_mask:0xf
  v_cndmask_b32_dpp v70, v110, v102, vcc quad_perm:[2,3,0,1] row_mask:0xf bank_mask:0xf
  v_cndmask_b32_dpp v67, v107, v99, vcc quad_perm:[2,3,0,1] row_mask:0xf bank_mask:0xf
  v_cndmask_b32_dpp v71, v111, v103, vcc quad_perm:[2,3,0,1] row_mask:0xf bank_mask:0xf
  s_waitcnt vmcnt(0)
  s_mov_b64 vcc, s[44:45]
  v_cndmask_b32_dpp v100, v80, v84, vcc quad_perm:[1,0,3,2] row_mask:0xf bank_mask:0xf
  v_cndmask_b32_dpp v108, v88, v92, vcc quad_perm:[1,0,3,2] row_mask:0xf bank_mask:0xf
  v_cndmask_b32_dpp v101, v81, v85, vcc quad_perm:[1,0,3,2] row_mask:0xf bank_mask:0xf
  v_cndmask_b32_dpp v109, v89, v93, vcc quad_perm:[1,0,3,2] row_mask:0xf bank_mask:0xf
  v_cndmask_b32_dpp v102, v82, v86, vcc quad_perm:[1,0,3,2] row_mask:0xf bank_mask:0xf
  v_cndmask_b32_dpp v110, v90, v94, vcc quad_perm:[1,0,3,2] row_mask:0xf bank_mask:0xf
  v_cndmask_b32_dpp v103, v83, v87, vcc quad_perm:[1,0,3,2] row_mask:0xf bank_mask:0xf
  v_cndmask_b32_dpp v111, v91, v95, vcc quad_perm:[1,0,3,2] row_mask:0xf bank_mask:0xf
  s_not_b64 vcc, vcc
  v_cndmask_b32_dpp v96, v84, v80, vcc quad_perm:[1,0,3,2] row_mask:0xf bank_mask:0xf
  v_cndmask_b32_dpp v104, v92, v88, vcc quad_perm:[1,0,3,2] row_mask:0xf bank_mask:0xf
  v_cndmask_b32_dpp v97, v85, v81, vcc quad_perm:[1,0,3,2] row_mask:0xf bank_mask:0xf
  v_cndmask_b32_dpp v105, v93, v89, vcc quad_perm:[1,0,3,2] row_mask:0xf bank_mask:0xf
  v_cndmask_b32_dpp v98, v86, v82, vcc quad_perm:[1,0,3,2] row_mask:0xf bank_mask:0xf
  v_cndmask_b32_dpp v106, v94, v90, vcc quad_perm:[1,0,3,2] row_mask:0xf bank_mask:0xf
  v_cndmask_b32_dpp v99, v87, v83, vcc quad_perm:[1,0,3,2] row_mask:0xf bank_mask:0xf
  v_cndmask_b32_dpp v107, v95, v91, vcc quad_perm:[1,0,3,2] row_mask:0xf bank_mask:0xf
  s_mov_b64 vcc, s[46:47]
  v_cndmask_b32_dpp v88, v96, v104, vcc quad_perm:[2,3,0,1] row_mask:0xf bank_mask:0xf
  v_cndmask_b32_dpp v92, v100, v108, vcc quad_perm:[2,3,0,1] row_mask:0xf bank_mask:0xf
  v_cndmask_b32_dpp v89, v97, v105, vcc quad_perm:[2,3,0,1] row_mask:0xf bank_mask:0xf
  v_cndmask_b32_dpp v93, v101, v109, vcc quad_perm:[2,3,0,1] row_mask:0xf bank_mask:0xf
  v_cndmask_b32_dpp v90, v98, v106, vcc quad_perm:[2,3,0,1] row_mask:0xf bank_mask:0xf
  v_cndmask_b32_dpp v94, v102, v110, vcc quad_perm:[2,3,0,1] row_mask:0xf bank_mask:0xf
  v_cndmask_b32_dpp v91, v99, v107, vcc quad_perm:[2,3,0,1] row_mask:0xf bank_mask:0xf
  v_cndmask_b32_dpp v95, v103, v111, vcc quad_perm:[2,3,0,1] row_mask:0xf bank_mask:0xf
  s_not_b64 vcc, vcc
  v_cndmask_b32_dpp v80, v104, v96, vcc quad_perm:[2,3,0,1] row_mask:0xf bank_mask:0xf
  v_cndmask_b32_dpp v84, v108, v100, vcc quad_perm:[2,3,0,1] row_mask:0xf bank_mask:0xf
  v_cndmask_b32_dpp v81, v105, v97, vcc quad_perm:[2,3,0,1] row_mask:0xf bank_mask:0xf
  v_cndmask_b32_dpp v85, v109, v101, vcc quad_perm:[2,3,0,1] row_mask:0xf bank_mask:0xf
  v_cndmask_b32_dpp v82, v106, v98, vcc quad_perm:[2,3,0,1] row_mask:0xf bank_mask:0xf
  v_cndmask_b32_dpp v86, v110, v102, vcc quad_perm:[2,3,0,1] row_mask:0xf bank_mask:0xf
  v_cndmask_b32_dpp v83, v107, v99, vcc quad_perm:[2,3,0,1] row_mask:0xf bank_mask:0xf
  v_cndmask_b32_dpp v87, v111, v103, vcc quad_perm:[2,3,0,1] row_mask:0xf bank_mask:0xf
  s_setprio 2
  s_or_b32 s54, s54, 31
L_poll_11:
  s_and_b32 s66, s54, 31
  s_cselect_b32 s66, 1048576, 0
  s_add_u32 s66, s66, s59
  buffer_load_dwordx4 v[16:19], v8, s[32:35], s66 offen offset:0 sc1
  s_sub_u32 s54, s54, 1
  s_cbranch_scc1 L_end
  s_waitcnt vmcnt(0)
  v_cmp_ne_u32 vcc, s48, v19
  s_nop 0
  s_mov_b64 exec, vcc
  s_cbranch_vccnz L_poll_11
  s_mov_b64 exec, -1
L_q_got:
  v_perm_b32 v19, v17, v16, s64
  v_perm_b32 v19, v18, v19, s65
  v_permlane32_swap_b32 v16, v18
  s_nop 0
  v_permlane32_swap_b32 v17, v19
  v_pk_add_f32 v[16:17], v[16:17], v[18:19]
  v_cvt_pk_bf16_f32 v16, v16, v17
  ds_write_b32 v9, v16 offset:12544
  ds_write_b32 v162, v161 offset:3200
L_lw_12:
  ds_read_b32 v16, v163 offset:3200
  ds_read_b128 v[96:99], v12 offset:12544
  ds_read_b128 v[100:103], v12 offset:12560
  ds_read_b128 v[104:107], v12 offset:12576
  ds_read_b128 v[108:111], v12 offset:12592
  s_sub_u32 s54, s54, 1
  s_cbranch_scc1 L_end
  s_waitcnt lgkmcnt(0)
  v_cmp_eq_u32 vcc, 0, v16
  s_nop 0
  s_cbranch_vccnz L_lw_12
  v_mfma_f32_16x16x32_bf16 v[112:115], v[32:35], v[96:99], 0
  v_mfma_f32_16x16x32_bf16 v[116:119], v[48:51], v[96:99], 0
  v_mfma_f32_16x16x32_bf16 v[120:123], v[64:67], v[96:99], 0
  v_mfma_f32_16x16x32_bf16 v[124:127], v[80:83], v[96:99], 0
  v_mfma_f32_16x16x32_bf16 v[112:115], v[36:39], v[100:103], v[112:115]
  v_mfma_f32_16x16x32_bf16 v[116:119], v[52:55], v[100:103], v[116:119]
  v_mfma_f32_16x16x32_bf16 v[120:123], v[68:71], v[100:103], v[120:123]
  v_mfma_f32_16x16x32_bf16 v[124:127], v[84:87], v[100:103], v[124:127]
  v_mfma_f32_16x16x32_bf16 v[112:115], v[40:43], v[104:107], v[112:115]
  v_mfma_f32_16x16x32_bf16 v[116:119], v[56:59], v[104:107], v[116:119]
  v_mfma_f32_16x16x32_bf16 v[120:123], v[72:75], v[104:107], v[120:123]
  v_mfma_f32_16x16x32_bf16 v[124:127], v[88:91], v[104:107], v[124:127]
  v_mfma_f32_16x16x32_bf16 v[112:115], v[44:47], v[108:111], v[112:115]
  v_mfma_f32_16x16x32_bf16 v[116:119], v[60:63], v[108:111], v[116:119]
  v_mfma_f32_16x16x32_bf16 v[120:123], v[76:79], v[108:111], v[120:123]
  v_mfma_f32_16x16x32_bf16 v[124:127], v[92:95], v[108:111], v[124:127]
  s_nop 5
  v_mov_b32_dpp v112, v116 quad_perm:[0,1,2,3] row_mask:0xf bank_mask:0x2
  v_mov_b32_dpp v113, v117 quad_perm:[0,1,2,3] row_mask:0xf bank_mask:0x2
  v_mov_b32_dpp v114, v118 quad_perm:[0,1,2,3] row_mask:0xf bank_mask:0x2
  v_mov_b32_dpp v115, v119 quad_perm:[0,1,2,3] row_mask:0xf bank_mask:0x2
  v_mov_b32_dpp v112, v120 quad_perm:[0,1,2,3] row_mask:0xf bank_mask:0x4
  v_mov_b32_dpp v113, v121 quad_perm:[0,1,2,3] row_mask:0xf bank_mask:0x4
  v_mov_b32_dpp v114, v122 quad_perm:[0,1,2,3] row_mask:0xf bank_mask:0x4
  v_mov_b32_dpp v115, v123 quad_perm:[0,1,2,3] row_mask:0xf bank_mask:0x4
  v_mov_b32_dpp v112, v124 quad_perm:[0,1,2,3] row_mask:0xf bank_mask:0x8
  v_mov_b32_dpp v113, v125 quad_perm:[0,1,2,3] row_mask:0xf bank_mask:0x8
  v_mov_b32_dpp v114, v126 quad_perm:[0,1,2,3] row_mask:0xf bank_mask:0x8
  v_mov_b32_dpp v115, v127 quad_perm:[0,1,2,3] row_mask:0xf bank_mask:0x8
  v_cvt_pk_bf16_f32 v16, v112, v113
  v_lshlrev_b32 v112, 16, v16
  v_and_b32 v113, s60, v16
  v_cvt_pk_bf16_f32 v16, v114, v115
  v_lshlrev_b32 v114, 16, v16
  v_and_b32 v115, s60, v16
  v_mul_f32 v112, 0x3db504f3, v112
  v_mul_f32 v113, 0x3db504f3, v113
  v_mul_f32 v114, 0x3db504f3, v114
  v_mul_f32 v115, 0x3db504f3, v115
  v_cvt_pk_bf16_f32 v16, v112, v113
  v_lshlrev_b32 v112, 16, v16
  v_and_b32 v113, s60, v16
  v_cvt_pk_bf16_f32 v16, v114, v115
  v_lshlrev_b32 v114, 16, v16
  v_and_b32 v115, s60, v16
  v_max3_f32 v16, v112, v113, v114
  v_max_f32 v16, v16, v115
  s_nop 1
  v_max_f32_dpp v16, v16, v16 row_ror:4 row_mask:0xf bank_mask:0xf
  s_nop 1
  v_max_f32_dpp v16, v16, v16 row_ror:8 row_mask:0xf bank_mask:0xf
  v_mov_b32 v18, v16
  s_nop 1
  v_permlane16_swap_b32 v16, v18
  v_max_f32 v16, v16, v18
  v_mov_b32 v18, v16
  s_nop 1
  v_permlane32_swap_b32 v16, v18
  v_max_f32 v16, v16, v18
  v_sub_f32 v112, v112, v16
  v_sub_f32 v113, v113, v16
  v_sub_f32 v114, v114, v16
  v_sub_f32 v115, v115, v16
  v_mul_f32 v112, 0x3fb8aa3b, v112
  v_mul_f32 v113, 0x3fb8aa3b, v113
  v_mul_f32 v114, 0x3fb8aa3b, v114
  v_mul_f32 v115, 0x3fb8aa3b, v115
  v_exp_f32 v112, v112
  v_exp_f32 v113, v113
  v_exp_f32 v114, v114
  v_exp_f32 v115, v115
  v_cvt_pk_bf16_f32 v20, v112, v113
  v_cvt_pk_bf16_f32 v21, v114, v115
  ds_write_b64 v13, v[20:21] offset:1024
  v_add_f32 v17, v112, v113
  v_add_f32 v18, v114, v115
  v_add_f32 v17, v17, v18
  s_nop 1
  v_add_f32_dpp v17, v17, v17 row_ror:4 row_mask:0xf bank_mask:0xf
  s_nop 1
  v_add_f32_dpp v17, v17, v17 row_ror:8 row_mask:0xf bank_mask:0xf
  v_mov_b32 v18, v17
  s_nop 1
  v_permlane16_swap_b32 v17, v18
  v_add_f32 v17, v17, v18
  v_mov_b32 v18, v17
  s_nop 1
  v_permlane32_swap_b32 v17, v18
  v_add_f32 v17, v17, v18
  s_mov_b64 exec, 15
  ds_write_b64 v14, v[16:17] offset:3072
  ds_write_b32 v162, v161 offset:3216
  s_mov_b64 exec, -1
  s_cmp_lg_u32 s49, 0
  s_cbranch_scc1 L_k_fin
  v_lshlrev_b32 v15, 5, v3
  v_lshl_add_u32 v15, v6, 3, v15
  s_lshl_b32 s52, s57, 17
  s_lshl_b32 s53, s58, 4
  s_add_u32 s59, s52, s53
  s_add_u32 s59, s59, 2170880
  v_lshlrev_b32 v18, 8, v3
  v_mov_b32 v26, s48
  v_mov_b32 v27, s48
L_lw_13:
  ds_read_b32 v19, v163 offset:3216
  ds_read_b64 v[16:17], v15 offset:3072
  s_sub_u32 s54, s54, 1
  s_cbranch_scc1 L_end
  s_waitcnt lgkmcnt(0)
  v_cmp_eq_u32 vcc, 0, v19
  s_nop 0
  s_cbranch_vccnz L_lw_13
  v_max_f32_dpp v24, v16, v16 quad_perm:[1,0,3,2] row_mask:0xf bank_mask:0xf
  s_nop 1
  v_max_f32_dpp v24, v24, v24 quad_perm:[2,3,0,1] row_mask:0xf bank_mask:0xf
  v_sub_f32 v16, v16, v24
  v_mul_f32 v16, 0x3fb8aa3b, v16
  v_exp_f32 v16, v16
  s_nop 0
  v_mul_f32 v25, v16, v17
  s_nop 1
  v_add_f32_dpp v25, v25, v25 quad_perm:[1,0,3,2] row_mask:0xf bank_mask:0xf
  s_nop 1
  v_add_f32_dpp v25, v25, v25 quad_perm:[2,3,0,1] row_mask:0xf bank_mask:0xf
  s_mov_b32 exec_lo, 0x00010001
  s_mov_b32 exec_hi, 0x00010001
  s_add_u32 s52, s59, 1048576
  buffer_store_dwordx4 v[24:27], v18, s[32:35], s52 offen
  buffer_store_dwordx4 v[24:27], v18, s[32:35], s59 offen sc1
  s_mov_b64 exec, -1
L_k_fin:
  s_setprio 0
  s_barrier
L_bar_end:
  s_barrier
  s_branch L_end
L_k_pf:
  s_setprio 0
  s_lshr_b32 s52, s58, 2
  s_mul_i32 s53, s52, 1
  s_add_u32 s53, s53, s57
  s_and_b32 s53, s53, 7
  s_lshl_b32 s52, s52, 3
  s_add_u32 s52, s52, s53
  s_cmp_ge_u32 s52, 28
  s_cbranch_scc1 L_bar_end
  s_and_b32 s53, s58, 3
  s_lshl_b32 s66, s52, 16
  s_lshl_b32 s67, s53, 14
  s_add_u32 s66, s66, s67
  s_add_u32 s68, s66, 8192
  s_mul_i32 s67, s53, 458752
  s_lshl_b32 s52, s52, 7
  s_add_u32 s67, s67, s52
  v_lshlrev_b32 v16, 7, v1
  v_bfe_u32 v17, v1, 3, 2
  v_and_b32 v18, 7, v1
  v_lshl_add_u32 v17, v17, 5, v18
  v_lshrrev_b32 v18, 5, v1
  v_lshlrev_b32 v18, 3, v18
  v_sub_u32 v17, v17, v18
  v_add_u32 v17, 24, v17
  v_mul_u32_u24 v17, 3584, v17
  v_and_b32 v163, 4, v163
  s_mov_b32 s36, s20
  s_mov_b32 s37, s21
  s_mov_b32 s38, 1835008
  s_mov_b32 s39, 0x20000
  s_mov_b32 s40, s16
  s_mov_b32 s41, s17
  s_mov_b32 s42, 1835008
  s_mov_b32 s43, 0x20000
  s_mov_b32 s44, s18
  s_mov_b32 s45, s19
  s_mov_b32 s46, 1835008
  s_mov_b32 s47, 0x20000
  s_barrier
  buffer_load_dword v20, v17, s[40:43], s67 offen
  buffer_load_dword v21, v17, s[44:47], s67 offen
  s_mov_b64 exec, -1
L_pf_dn:
  buffer_load_dword v22, v16, s[36:39], s66 offen
  buffer_load_dword v23, v16, s[36:39], s68 offen
  s_branch L_end
L_vwave:
  v_lshlrev_b32 v7, 4, v1
  v_lshlrev_b32 v13, 2, v1
  v_mov_b32 v14, 0
  ds_write_b32 v13, v14 offset:3200
  ds_write_b32 v13, v14 offset:3456
  ds_write_b32 v13, v14 offset:3712
  s_mov_b32 s32, s30
  s_mov_b32 s33, s31
  s_mov_b32 s36, s8
  s_mov_b32 s37, s9
  v_lshlrev_b32 v8, 6, v6
  v_lshl_add_u32 v8, v3, 4, v8
  s_lshl_b32 s52, s69, 9
  s_add_u32 s52, s52, 1024
  v_add_u32 v8, s52, v8
  v_mov_b32 v15, 3456
  v_cmp_eq_u32 vcc, 0, v5
  s_nop 1
  v_cndmask_b32 v164, v15, v8, vcc
  v_cmp_eq_u32 vcc, 1, v5
  s_nop 1
  v_cndmask_b32 v165, v15, v8, vcc
  v_cmp_eq_u32 vcc, 2, v5
  s_nop 1
  v_cndmask_b32 v166, v15, v8, vcc
  v_cmp_eq_u32 vcc, 3, v5
  s_nop 1
  v_cndmask_b32 v167, v15, v8, vcc
  s_lshl_b32 s52, s69, 10
  v_add_u32 v10, s52, v7
  v_lshrrev_b32 v12, 5, v1
  s_lshl_b32 s52, s69, 1
  v_add_u32 v12, s52, v12
  v_and_b32 v12, 3, v12
  v_lshlrev_b32 v9, 5, v12
  v_bfe_u32 v11, v1, 1, 4
  v_lshl_add_u32 v11, v11, 2, v12
  v_lshlrev_b32 v11, 4, v11
  v_and_b32 v13, 1, v1
  v_mul_u32_u24 v13, 4128, v13
  v_add_u32 v11, v11, v13
  v_lshlrev_b32 v12, 13, v12
  v_and_b32 v13, 31, v1
  v_lshl_add_u32 v12, v13, 4, v12
  s_lshl_b32 s52, s57, 17
  s_lshl_b32 s53, s58, 9
  s_add_u32 s52, s52, s53
  s_add_u32 s66, s52, 2195456
  s_add_u32 s67, s66, 1048576
  v_lshlrev_b32 v13, 2, v6
  s_lshl_b32 s52, s69, 2
  v_mov_b32 v14, s52
  v_mov_b32 v15, 1
  s_cmp_ge_u32 s69, 2
  s_cbranch_scc1 L_v_pt2
  buffer_load_dword v160, v12, s[32:35], s67 offen
  s_branch L_v_pt3
L_v_pt2:
  s_cmp_lg_u32 s69, 2
  s_cbranch_scc1 L_v_pt3
  s_lshl_b32 s52, s57, 17
  s_add_u32 s52, s52, 3219456
  buffer_load_dword v160, v7, s[32:35], s52 offen
L_v_pt3:
  v_mov_b32 v31, s48
  s_waitcnt lgkmcnt(0)
  s_barrier
  s_xor_b32 s52, s59, 0
  buffer_load_dwordx4 v[32:35], v7, s[36:39], s52 offen nt
  s_xor_b32 s52, s59, 4096
  buffer_load_dwordx4 v[36:39], v7, s[36:39], s52 offen nt
  s_xor_b32 s52, s59, 8192
  buffer_load_dwordx4 v[40:43], v7, s[36:39], s52 offen nt
  s_xor_b32 s52, s59, 12288
  buffer_load_dwordx4 v[44:47], v7, s[36:39], s52 offen nt
  s_xor_b32 s52, s59, 16384
  buffer_load_dwordx4 v[48:51], v7, s[36:39], s52 offen nt
  s_xor_b32 s52, s59, 20480
  buffer_load_dwordx4 v[52:55], v7, s[36:39], s52 offen nt
  s_waitcnt vmcnt(5)
  s_xor_b32 s52, s59, 24576
  buffer_load_dwordx4 v[56:59], v7, s[36:39], s52 offen nt
  s_waitcnt vmcnt(5)
  s_xor_b32 s52, s59, 28672
  buffer_load_dwordx4 v[60:63], v7, s[36:39], s52 offen nt
  v_perm_b32 v96, v36, v32, s50
  v_perm_b32 v100, v36, v32, s51
  v_perm_b32 v104, v37, v33, s50
  v_perm_b32 v108, v37, v33, s51
  v_perm_b32 v112, v38, v34, s50
  v_perm_b32 v116, v38, v34, s51
  v_perm_b32 v120, v39, v35, s50
  v_perm_b32 v124, v39, v35, s51
  s_waitcnt vmcnt(5)
  s_xor_b32 s52, s59, 32768
  buffer_load_dwordx4 v[64:67], v7, s[36:39], s52 offen nt
  s_waitcnt vmcnt(5)
  s_xor_b32 s52, s59, 36864
  buffer_load_dwordx4 v[68:71], v7, s[36:39], s52 offen nt
  v_perm_b32 v97, v44, v40, s50
  v_perm_b32 v101, v44, v40, s51
  v_perm_b32 v105, v45, v41, s50
  v_perm_b32 v109, v45, v41, s51
  v_perm_b32 v113, v46, v42, s50
  v_perm_b32 v117, v46, v42, s51
  v_perm_b32 v121, v47, v43, s50
  v_perm_b32 v125, v47, v43, s51
  s_waitcnt vmcnt(5)
  s_xor_b32 s52, s59, 40960
  buffer_load_dwordx4 v[72:75], v7, s[36:39], s52 offen nt
  s_waitcnt vmcnt(5)
  s_xor_b32 s52, s59, 45056
  buffer_load_dwordx4 v[76:79], v7, s[36:39], s52 offen nt
  v_perm_b32 v98, v52, v48, s50
  v_perm_b32 v102, v52, v48, s51
  v_perm_b32 v106, v53, v49, s50
  v_perm_b32 v110, v53, v49, s51
  v_perm_b32 v114, v54, v50, s50
  v_perm_b32 v118, v54, v50, s51
  v_perm_b32 v122, v55, v51, s50
  v_perm_b32 v126, v55, v51, s51
  s_waitcnt vmcnt(5)
  s_xor_b32 s52, s59, 49152
  buffer_load_dwordx4 v[80:83], v7, s[36:39], s52 offen nt
  s_waitcnt vmcnt(5)
  s_xor_b32 s52, s59, 53248
  buffer_load_dwordx4 v[84:87], v7, s[36:39], s52 offen nt
  v_perm_b32 v99, v60, v56, s50
  v_perm_b32 v103, v60, v56, s51
  v_perm_b32 v107, v61, v57, s50
  v_perm_b32 v111, v61, v57, s51
  v_perm_b32 v115, v62, v58, s50
  v_perm_b32 v119, v62, v58, s51
  v_perm_b32 v123, v63, v59, s50
  v_perm_b32 v127, v63, v59, s51
  s_waitcnt vmcnt(5)
  s_xor_b32 s52, s59, 57344
  buffer_load_dwordx4 v[88:91], v7, s[36:39], s52 offen nt
  s_waitcnt vmcnt(5)
  s_xor_b32 s52, s59, 61440
  buffer_load_dwordx4 v[92:95], v7, s[36:39], s52 offen nt
  s_waitcnt vmcnt(6)
  v_perm_b32 v32, v68, v64, s50
  v_perm_b32 v36, v68, v64, s51
  v_perm_b32 v40, v69, v65, s50
  v_perm_b32 v44, v69, v65, s51
  v_perm_b32 v48, v70, v66, s50
  v_perm_b32 v52, v70, v66, s51
  v_perm_b32 v56, v71, v67, s50
  v_perm_b32 v60, v71, v67, s51
  s_waitcnt vmcnt(4)
  v_perm_b32 v33, v76, v72, s50
  v_perm_b32 v37, v76, v72, s51
  v_perm_b32 v41, v77, v73, s50
  v_perm_b32 v45, v77, v73, s51
  v_perm_b32 v49, v78, v74, s50
  v_perm_b32 v53, v78, v74, s51
  v_perm_b32 v57, v79, v75, s50
  v_perm_b32 v61, v79, v75, s51
  s_waitcnt vmcnt(2)
  v_perm_b32 v34, v84, v80, s50
  v_perm_b32 v38, v84, v80, s51
  v_perm_b32 v42, v85, v81, s50
  v_perm_b32 v46, v85, v81, s51
  v_perm_b32 v50, v86, v82, s50
  v_perm_b32 v54, v86, v82, s51
  v_perm_b32 v58, v87, v83, s50
  v_perm_b32 v62, v87, v83, s51
L_lw_14:
  ds_read_b32 v24, v13 offset:3216
  ds_read_b128 v[128:131], v164 offset:0
  ds_read_b128 v[132:135], v165 offset:0
  ds_read_b128 v[136:139], v166 offset:0
  ds_read_b128 v[140:143], v167 offset:0
  ds_read_b128 v[144:147], v164 offset:256
  ds_read_b128 v[148:151], v165 offset:256
  ds_read_b128 v[152:155], v166 offset:256
  ds_read_b128 v[156:159], v167 offset:256
  ds_read_b128 v[64:67], v9 offset:3072
  ds_read_b128 v[68:71], v9 offset:3088
  s_sub_u32 s54, s54, 1
  s_cbranch_scc1 L_end
  s_waitcnt lgkmcnt(0)
  v_cmp_eq_u32 vcc, 0, v24
  s_nop 0
  s_cbranch_vccnz L_lw_14
  s_setprio 3
  v_mfma_f32_16x16x32_bf16 v[16:19], v[96:99], v[128:131], 0
  v_max3_f32 v72, v64, v66, v68
  v_max_f32 v72, v72, v70
  v_mfma_f32_16x16x32_bf16 v[20:23], v[100:103], v[128:131], 0
  v_sub_f32 v64, v64, v72
  v_sub_f32 v66, v66, v72
  v_mfma_f32_16x16x32_bf16 v[16:19], v[104:107], v[132:135], v[16:19]
  v_sub_f32 v68, v68, v72
  v_sub_f32 v70, v70, v72
  v_mfma_f32_16x16x32_bf16 v[20:23], v[108:111], v[132:135], v[20:23]
  v_mul_f32 v64, 0x3fb8aa3b, v64
  v_mul_f32 v66, 0x3fb8aa3b, v66
  v_mfma_f32_16x16x32_bf16 v[16:19], v[112:115], v[136:139], v[16:19]
  v_mul_f32 v68, 0x3fb8aa3b, v68
  v_mul_f32 v70, 0x3fb8aa3b, v70
  v_mfma_f32_16x16x32_bf16 v[20:23], v[116:119], v[136:139], v[20:23]
  v_exp_f32 v72, v64
  v_exp_f32 v74, v66
  v_mfma_f32_16x16x32_bf16 v[16:19], v[120:123], v[140:143], v[16:19]
  v_exp_f32 v76, v68
  v_exp_f32 v78, v70
  v_mfma_f32_16x16x32_bf16 v[20:23], v[124:127], v[140:143], v[20:23]
  v_mov_b32 v73, v72
  v_mov_b32 v75, v74
  v_mov_b32 v77, v76
  v_mov_b32 v79, v78
  s_waitcnt vmcnt(0)
  v_perm_b32 v35, v92, v88, s50
  v_perm_b32 v39, v92, v88, s51
  v_perm_b32 v43, v93, v89, s50
  v_perm_b32 v47, v93, v89, s51
  v_perm_b32 v51, v94, v90, s50
  v_perm_b32 v55, v94, v90, s51
  v_perm_b32 v59, v95, v91, s50
  v_perm_b32 v63, v95, v91, s51
  v_mfma_f32_16x16x32_bf16 v[16:19], v[32:35], v[144:147], v[16:19]
  v_mfma_f32_16x16x32_bf16 v[20:23], v[36:39], v[144:147], v[20:23]
  v_mfma_f32_16x16x32_bf16 v[16:19], v[40:43], v[148:151], v[16:19]
  v_mfma_f32_16x16x32_bf16 v[20:23], v[44:47], v[148:151], v[20:23]
  v_mfma_f32_16x16x32_bf16 v[16:19], v[48:51], v[152:155], v[16:19]
  v_mfma_f32_16x16x32_bf16 v[20:23], v[52:55], v[152:155], v[20:23]
  v_mfma_f32_16x16x32_bf16 v[16:19], v[56:59], v[156:159], v[16:19]
  v_mfma_f32_16x16x32_bf16 v[20:23], v[60:63], v[156:159], v[20:23]
  s_nop 6
  ds_write_b128 v10, v[16:19] offset:4096
  ds_write_b128 v10, v[20:23] offset:8224
  s_waitcnt lgkmcnt(0)
  s_barrier
  s_cmp_eq_u32 s69, 3
  s_cbranch_scc1 L_k_pf
  s_cmp_eq_u32 s69, 2
  s_cbranch_scc1 L_bar_end
  ds_read_b128 v[128:131], v11 offset:4096
  ds_read_b128 v[132:135], v11 offset:5120
  ds_read_b128 v[136:139], v11 offset:6144
  ds_read_b128 v[140:143], v11 offset:7168
  s_waitcnt lgkmcnt(0)
  v_pk_mul_f32 v[24:25], v[128:129], v[72:73]
  v_pk_mul_f32 v[26:27], v[130:131], v[72:73]
  v_pk_fma_f32 v[24:25], v[132:133], v[74:75], v[24:25]
  v_pk_fma_f32 v[26:27], v[134:135], v[74:75], v[26:27]
  v_pk_fma_f32 v[24:25], v[136:137], v[76:77], v[24:25]
  v_pk_fma_f32 v[26:27], v[138:139], v[76:77], v[26:27]
  v_pk_fma_f32 v[24:25], v[140:141], v[78:79], v[24:25]
  v_pk_fma_f32 v[26:27], v[142:143], v[78:79], v[26:27]
  v_perm_b32 v28, v24, v27, s61
  v_perm_b32 v29, v25, v27, s62
  v_perm_b32 v30, v26, v27, s63
  buffer_store_dwordx4 v[28:31], v12, s[32:35], s67 offen
  buffer_store_dwordx4 v[28:31], v12, s[32:35], s66 offen sc1
L_V_nosl:
  s_barrier
L_end:
L_exit:
  s_endpgm
L_spare:
  s_lshr_b32 s3, s49, 2
  s_mul_i32 s99, s3, 5376
L_spare_loop:
  s_sub_u32 s57, s98, 32
  s_mov_b32 s58, s3
  s_lshl_b32 s59, s57, 7
  s_add_u32 s59, s59, 2048
  s_lshl_b32 s56, s57, 8
  s_lshl_b32 s52, s58, 18
  s_add_u32 s56, s56, s52
  s_add_u32 s56, s56, 2129920
  s_mov_b32 s42, 1024
  s_waitcnt vmcnt(0)
  s_lshl_b32 s52, s58, 7
  s_lshl_b32 s53, s69, 5
  s_add_u32 s52, s52, s53
  v_lshlrev_b32 v7, 4, v5
  v_lshl_add_u32 v7, v3, 2, v7
  v_add_u32 v7, s52, v7
  v_lshlrev_b32 v8, 1, v7
  v_mul_u32_u24 v9, 6144, v7
  v_lshl_add_u32 v9, v6, 4, v9
  s_add_u32 s66, s59, 6144
  s_mov_b32 s38, 3145728
  s_add_u32 s67, s59, 12288
  s_add_u32 s68, s59, 18432
  s_mov_b32 s36, s24
  s_mov_b32 s37, s25
  s_mov_b32 s40, s22
  s_mov_b32 s41, s23
  buffer_load_dwordx2 v[10:11], v8, s[40:43], 0 offen
  buffer_load_dwordx4 v[32:35], v9, s[36:39], s59 offen nt
  buffer_load_dwordx4 v[36:39], v9, s[36:39], s66 offen nt
  buffer_load_dwordx4 v[40:43], v9, s[36:39], s67 offen nt
  buffer_load_dwordx4 v[44:47], v9, s[36:39], s68 offen nt
  v_and_b32 v12, 1, v2
  v_cmp_eq_u32 vcc, 1, v12
  v_mov_b32 v14, 0xffff
  v_mov_b32 v15, s60
  v_cndmask_b32 v14, v14, v15, vcc
  v_lshrrev_b32 v12, 1, v6
  v_cmp_eq_u32 vcc, 0, v12
  s_nop 1
  v_cndmask_b32 v16, 0, v14, vcc
  v_cmp_eq_u32 vcc, 1, v12
  s_nop 1
  v_cndmask_b32 v17, 0, v14, vcc
  v_cmp_eq_u32 vcc, 2, v12
  s_nop 1
  v_cndmask_b32 v18, 0, v14, vcc
  v_cmp_eq_u32 vcc, 3, v12
  s_nop 1
  v_cndmask_b32 v19, 0, v14, vcc
  v_and_b32 v13, 1, v3
  v_lshlrev_b32 v12, 3, v6
  v_lshl_add_u32 v12, v13, 2, v12
  v_mul_u32_u24 v12, 80, v12
  v_mad_u32_u24 v12, v6, 32, v12
  v_lshl_add_u32 v12, v5, 2, v12
  s_lshl_b32 s52, s69, 3
  s_add_u32 s52, s52, s99
  v_add_u32 v12, s52, v12
  v_lshlrev_b32 v15, 4, v2
  v_lshl_add_u32 v15, v3, 13, v15
  v_lshl_add_u32 v13, v2, 2, v3
  v_mul_u32_u24 v13, 80, v13
  v_lshrrev_b32 v4, 1, v2
  v_mad_u32_u24 v13, v4, 32, v13
  v_add_u32 v13, s99, v13
  v_mov_b32 v31, s48
  s_waitcnt vmcnt(4)
  v_lshlrev_b32 v20, 16, v10
  v_and_b32 v21, s60, v10
  v_lshlrev_b32 v22, 16, v11
  v_and_b32 v23, s60, v11
  v_mul_f32 v24, 0xbfb8aa3b, v20
  v_mul_f32 v25, 0xbfb8aa3b, v21
  v_mul_f32 v26, 0xbfb8aa3b, v22
  v_mul_f32 v27, 0xbfb8aa3b, v23
  v_exp_f32 v24, v24
  v_exp_f32 v25, v25
  v_exp_f32 v26, v26
  v_exp_f32 v27, v27
  v_add_f32 v24, 1.0, v24
  v_add_f32 v25, 1.0, v25
  v_add_f32 v26, 1.0, v26
  v_add_f32 v27, 1.0, v27
  v_rcp_f32 v24, v24
  v_rcp_f32 v25, v25
  v_rcp_f32 v26, v26
  v_rcp_f32 v27, v27
  v_mul_f32 v20, v20, v24
  v_mul_f32 v21, v21, v25
  v_mul_f32 v22, v22, v26
  v_mul_f32 v23, v23, v27
  v_cvt_pk_bf16_f32 v20, v20, v20
  v_cvt_pk_bf16_f32 v21, v21, v21
  v_cvt_pk_bf16_f32 v22, v22, v22
  v_cvt_pk_bf16_f32 v23, v23, v23
  v_and_b32 v48, v20, v16
  v_and_b32 v49, v20, v17
  v_and_b32 v50, v20, v18
  v_and_b32 v51, v20, v19
  s_waitcnt vmcnt(3)
  s_nop 0
  v_mfma_f32_16x16x32_bf16 v[64:67], v[48:51], v[32:35], 0
  v_and_b32 v52, v21, v16
  v_and_b32 v53, v21, v17
  v_and_b32 v54, v21, v18
  v_and_b32 v55, v21, v19
  s_waitcnt vmcnt(2)
  s_nop 0
  v_mfma_f32_16x16x32_bf16 v[64:67], v[52:55], v[36:39], v[64:67]
  v_and_b32 v56, v22, v16
  v_and_b32 v57, v22, v17
  v_and_b32 v58, v22, v18
  v_and_b32 v59, v22, v19
  s_waitcnt vmcnt(1)
  s_nop 0
  v_mfma_f32_16x16x32_bf16 v[64:67], v[56:59], v[40:43], v[64:67]
  v_and_b32 v60, v23, v16
  v_and_b32 v61, v23, v17
  v_and_b32 v62, v23, v18
  v_and_b32 v63, v23, v19
  s_waitcnt vmcnt(0)
  s_nop 0
  v_mfma_f32_16x16x32_bf16 v[64:67], v[60:63], v[44:47], v[64:67]
  s_mov_b32 exec_lo, 0x00FF00FF
  s_mov_b32 exec_hi, 0xFF00FF00
  s_nop 5
  ds_write2_b32 v12, v64, v65 offset0:0 offset1:20
  ds_write2_b32 v12, v66, v67 offset0:40 offset1:60
  s_mov_b64 exec, -1
  s_waitcnt lgkmcnt(0)
  s_barrier
  s_cmp_lg_u32 s69, 0
  s_cbranch_scc1 L_spare_d
  ds_read_b128 v[32:35], v13 offset:0
  ds_read_b128 v[36:39], v13 offset:16
  s_waitcnt lgkmcnt(0)
  v_pk_add_f32 v[32:33], v[32:33], v[36:37]
  v_pk_add_f32 v[34:35], v[34:35], v[38:39]
  v_pk_add_f32 v[32:33], v[32:33], v[34:35]
  v_add_f32 v20, v32, v33
  v_mov_b32 v21, v20
  s_nop 1
  v_permlane16_swap_b32 v20, v21
  v_mov_b32 v22, v20
  v_mov_b32 v23, v21
  s_nop 0
  v_permlane32_swap_b32 v20, v22
  v_permlane32_swap_b32 v21, v23
  v_perm_b32 v28, v20, v23, s61
  v_perm_b32 v29, v21, v23, s62
  v_perm_b32 v30, v22, v23, s63
  s_mov_b64 exec, 0xffff
  buffer_store_dwordx4 v[28:31], v15, s[32:35], s56 offen sc1
  s_mov_b64 exec, -1
L_spare_d:
  s_add_u32 s3, s3, 2
  s_cmp_ge_u32 s3, 4
  s_cbranch_scc1 L_end
  s_barrier
  s_branch L_spare_loop
.section .rodata,"a"
.p2align 6
.amdhsa_kernel adaLN_cond__sliding_block_cached__geglu_ffn__decode_kernel
  .amdhsa_next_free_vgpr 216
  .amdhsa_next_free_sgpr 102
  .amdhsa_accum_offset 216
  .amdhsa_group_segment_fixed_size 0
  .amdhsa_kernarg_size 112
  .amdhsa_user_sgpr_count 2
  .amdhsa_user_sgpr_kernarg_segment_ptr 1
  .amdhsa_system_sgpr_workgroup_id_x 1
  .amdhsa_float_denorm_mode_32 3
.end_amdhsa_kernel
```
